```python
import torch

def _softmax(x, axis=-1):
    return torch.softmax(x, dim=axis)
def _gelu(x):
    return torch.nn.functional.gelu(x, approximate="tanh")
def _silu(x):
    return torch.nn.functional.silu(x)
def _sigmoid(x):
    return torch.sigmoid(x)
def _layernorm(x, axis=-1, eps=1e-5):
    m = x.mean(dim=axis, keepdim=True)
    v = x.var(dim=axis, keepdim=True, unbiased=False)
    return (x - m) / torch.sqrt(v + eps)
def _scatter_add(tgt, idx, src, axis=0):
    return tgt.clone().index_add_(axis, idx, src)
def _segment_sum(src, seg, n):
    out = torch.zeros((n,) + src.shape[1:], dtype=src.dtype)
    return out.index_add_(0, seg, src)
def _pad(x, pw):
    flat = tuple(v for pair in reversed(pw) for v in pair)
    return torch.nn.functional.pad(x, flat)

kernel_name = 'concat_heads__gqa_block_cached__gqa_block_cached__near_ridge'

def setup_inputs():

    _w = (lambda a: (lambda t: t.to(torch.bfloat16) if t.is_floating_point() else t)(torch.as_tensor(a)))
    def _A_setup():
        B, Sq, D = 8, 64, 512
        Hq, Hkv, Sk, Dh = 32, 8, 2048, 128
        assert Hq % Hkv == 0, (Hq, Hkv)
        return {
            "x": _w((lambda *s: torch.randn(*s, dtype=torch.bfloat16) * 0.8)(B, Sq, D)),
            "k_cache": _w((lambda *s: torch.randn(*s, dtype=torch.bfloat16) * 0.8)(B, Hkv, Sk, Dh)),
            "v_cache": _w((lambda *s: torch.randn(*s, dtype=torch.bfloat16) * 0.05)(B, Hkv, Sk, Dh)),
            "wq": _w((lambda *s: torch.randn(*s, dtype=torch.bfloat16) * 0.8)(D, Hq * Dh) * (D ** -0.5)),
            "wo": _w((lambda *s: torch.randn(*s, dtype=torch.bfloat16) * 0.05)(Hq * Dh, D) * ((Hq * Dh) ** -0.5)),
        }
    _A_in = _A_setup()

    def _B_setup():
        B, Sq, D = 8, 64, 512
        Hq, Hkv, Sk, Dh = 32, 8, 2048, 128
        assert Hq % Hkv == 0, (Hq, Hkv)
        return {
            "x": _w((lambda *s: torch.randn(*s, dtype=torch.bfloat16) * 0.8)(B, Sq, D)),
            "k_cache": _w((lambda *s: torch.randn(*s, dtype=torch.bfloat16) * 0.8)(B, Hkv, Sk, Dh)),
            "v_cache": _w((lambda *s: torch.randn(*s, dtype=torch.bfloat16) * 0.05)(B, Hkv, Sk, Dh)),
            "wq": _w((lambda *s: torch.randn(*s, dtype=torch.bfloat16) * 0.8)(D, Hq * Dh) * (D ** -0.5)),
            "wo": _w((lambda *s: torch.randn(*s, dtype=torch.bfloat16) * 0.05)(Hq * Dh, D) * ((Hq * Dh) ** -0.5)),
        }
    _B_in = _B_setup()

    return {
        "A_x": _A_in["x"],
        "A_k_cache": _A_in["k_cache"],
        "A_v_cache": _A_in["v_cache"],
        "A_wq": _A_in["wq"],
        "A_wo": _A_in["wo"],
        "B_x": _B_in["x"],
        "B_k_cache": _B_in["k_cache"],
        "B_v_cache": _B_in["v_cache"],
        "B_wq": _B_in["wq"],
        "B_wo": _B_in["wo"],
    }

def reference(A_x, A_k_cache, A_v_cache, A_wq, A_wo, B_x, B_k_cache, B_v_cache, B_wq, B_wo):
    def _A_ref(x, k_cache, v_cache, wq, wo):
        B, Sq, D = x.shape
        Hq, Dh = 32, 128
        Hkv = k_cache.shape[1]
        rep = Hq // Hkv
        q = (lambda x, *d: x.permute(*d))((x @ wq).reshape(B, Sq, Hq, Dh), 0, 2, 1, 3)
        k = (lambda x, n, axis: torch.repeat_interleave(x, n, dim=axis))(k_cache, rep, axis=1)
        v = (lambda x, n, axis: torch.repeat_interleave(x, n, dim=axis))(v_cache, rep, axis=1)
        scores = torch.einsum("bhqd,bhkd->bhqk", q, k) * (Dh ** -0.5)
        p = _softmax(scores, axis=-1)
        o = torch.einsum("bhqk,bhkd->bhqd", p, v)
        return (lambda x, *d: x.permute(*d))(o, 0, 2, 1, 3).reshape(B, Sq, Hq * Dh) @ wo

    def _B_ref(x, k_cache, v_cache, wq, wo):
        B, Sq, D = x.shape
        Hq, Dh = 32, 128
        Hkv = k_cache.shape[1]
        rep = Hq // Hkv
        q = (lambda x, *d: x.permute(*d))((x @ wq).reshape(B, Sq, Hq, Dh), 0, 2, 1, 3)
        k = (lambda x, n, axis: torch.repeat_interleave(x, n, dim=axis))(k_cache, rep, axis=1)
        v = (lambda x, n, axis: torch.repeat_interleave(x, n, dim=axis))(v_cache, rep, axis=1)
        scores = torch.einsum("bhqd,bhkd->bhqk", q, k) * (Dh ** -0.5)
        p = _softmax(scores, axis=-1)
        o = torch.einsum("bhqk,bhkd->bhqd", p, v)
        return (lambda x, *d: x.permute(*d))(o, 0, 2, 1, 3).reshape(B, Sq, Hq * Dh) @ wo

    a = _A_ref(A_x, A_k_cache, A_v_cache, A_wq, A_wo)
    b = _B_ref(B_x, B_k_cache, B_v_cache, B_wq, B_wo)
    return torch.concatenate([a, b], axis=-1)
```

```asm
; @launch grid=(256,1,1) block=(256,1,1) lds=163840
.amdgcn_target "amdgcn-amd-amdhsa--gfx950"
.text
.globl concat_heads__gqa_block_cached__gqa_block_cached__near_ridge_kernel
.p2align 8
.type concat_heads__gqa_block_cached__gqa_block_cached__near_ridge_kernel,@function
concat_heads__gqa_block_cached__gqa_block_cached__near_ridge_kernel:
    s_cmp_ge_u32 s2, 256
    s_cbranch_scc1 L_end
    s_load_dwordx16 s[36:51], s[0:1], 0
    s_load_dwordx8 s[52:59], s[0:1], 64
    s_load_dwordx2 s[60:61], s[0:1], 96
    s_getpc_b64 s[30:31]
L_pc:
    s_lshr_b32 s64, s2, 3
    v_lshrrev_b32 v6, 4, v0
    v_lshl_add_u32 v6, s64, 4, v6
    v_lshlrev_b32 v6, 7, v6
    v_min_u32 v6, L_end-L_pc, v6
    global_load_dword v15, v6, s[30:31]
    v_lshrrev_b32 v1, 6, v0
    v_and_b32 v2, 63, v0
    v_readfirstlane_b32 s28, v1
    v_lshrrev_b32 v3, 4, v2
    v_lshrrev_b32 v5, 5, v2
    v_bfe_u32 v6, v2, 3, 2
    v_lshl_add_u32 v5, v5, 3, v6
    v_lshlrev_b32 v6, 1, v3
    v_and_b32 v7, 7, v2
    v_xor_b32 v6, v6, v7
    v_lshlrev_b32 v6, 4, v6
    v_lshl_add_u32 v6, v1, 7, v6
    v_lshl_add_u32 v36, v5, 13, v6
    v_add_u32 v37, 130048, v36
    v_add_u32 v38, 30720, v36
    v_add_u32 v39, 160768, v36
    s_lshr_b32 s34, s2, 5
    s_bfe_u32 s63, s2, 0x20003
    s_and_b32 s35, s2, 3
    s_lshl2_add_u32 s35, s35, s63
    s_lshl_b32 s33, s28, 12
    s_cmp_le_u32 s34, 2
    s_cselect_b32 s67, s34, 0
    s_lshl_b32 s67, s67, 19
    s_lshl_b32 s65, s35, 9
    s_sub_u32 s18, 0x400000, s65
    s_mov_b32 s19, 0x20000
    s_bitcmp0_b32 s2, 2
    s_waitcnt lgkmcnt(0)
    s_cselect_b64 s[16:17], s[42:43], s[52:53]
    s_cselect_b64 s[4:5], s[36:37], s[46:47]
    s_cselect_b64 s[8:9], s[38:39], s[48:49]
    s_cselect_b64 s[12:13], s[40:41], s[50:51]
    s_cselect_b64 s[20:21], s[44:45], s[54:55]
    s_add_u32 s16, s16, s65
    s_addc_u32 s17, s17, 0
    s_add_u32 m0, s33, 0
    s_nop 0
    buffer_load_dwordx4 v36, s[16:19], s67 offen offset:0 lds
    buffer_load_dwordx4 v37, s[16:19], s67 offen offset:1024 lds
    buffer_load_dwordx4 v38, s[16:19], s67 offen offset:2048 lds
    buffer_load_dwordx4 v39, s[16:19], s67 offen offset:3072 lds
    s_xor_b32 s67, s67, 0x40000
    s_add_u32 m0, s33, 16384
    s_nop 0
    buffer_load_dwordx4 v36, s[16:19], s67 offen offset:0 lds
    buffer_load_dwordx4 v37, s[16:19], s67 offen offset:1024 lds
    buffer_load_dwordx4 v38, s[16:19], s67 offen offset:2048 lds
    buffer_load_dwordx4 v39, s[16:19], s67 offen offset:3072 lds
    s_mov_b32 s101, 0x76543210
    s_cmp_eq_u32 s34, 1
    s_cselect_b32 s101, 0x76543201, s101
    s_cmp_eq_u32 s34, 2
    s_cselect_b32 s101, 0x76543102, s101
    s_cmp_eq_u32 s34, 3
    s_cselect_b32 s101, 0x76542130, s101
    s_cmp_eq_u32 s34, 4
    s_cselect_b32 s101, 0x76532410, s101
    s_cmp_eq_u32 s34, 5
    s_cselect_b32 s101, 0x76435210, s101
    s_cmp_eq_u32 s34, 6
    s_cselect_b32 s101, 0x75463210, s101
    s_cmp_eq_u32 s34, 7
    s_cselect_b32 s101, 0x65743210, s101
    v_and_b32 v4, 15, v2
    v_lshl_add_u32 v5, v1, 4, v3
    v_xor_b32 v6, v3, v4
    v_lshlrev_b32 v92, 4, v6
    v_and_b32 v6, 0x70, v92
    v_lshl_add_u32 v88, v5, 10, v6
    v_add_u32 v90, 6144, v88
    v_xor_b32 v89, 64, v88
    v_add_u32 v91, 9216, v89
    v_add_u32 v89, 3072, v89
    v_bfe_u32 v112, v2, 3, 1
    v_xor_b32 v113, 1, v112
    s_mov_b32 s64, s101
    s_and_b32 s65, s64, 7
    s_lshl_b32 s65, s65, 7
    s_bfe_u32 s66, s64, 0x30004
    s_lshl_b32 s66, s66, 7
    v_mad_u32_u24 v56, v112, s66, v88
    v_mad_u32_u24 v56, v113, s65, v56
    v_mad_u32_u24 v57, v112, s66, v89
    v_mad_u32_u24 v57, v113, s65, v57
    v_mad_u32_u24 v58, v113, s66, v90
    v_mad_u32_u24 v58, v112, s65, v58
    v_mad_u32_u24 v59, v113, s66, v91
    v_mad_u32_u24 v59, v112, s65, v59
    s_bfe_u32 s67, s101, 0x30004
    s_lshl_b32 s67, s67, 19
    s_lshl_b32 s64, s34, 16
    s_add_u32 s4, s4, s64
    s_addc_u32 s5, s5, 0
    s_mov_b32 s6, 0x10000
    s_mov_b32 s7, 0x20000
    s_add_u32 m0, s33, 32768
    s_nop 0
    buffer_load_dwordx4 v56, s[4:7], 0 offen offset:0 lds
    buffer_load_dwordx4 v57, s[4:7], 0 offen offset:1024 lds
    buffer_load_dwordx4 v58, s[4:7], 0 offen offset:2048 lds
    buffer_load_dwordx4 v59, s[4:7], 0 offen offset:3072 lds
    s_cmp_eq_u32 s63, 3
    s_cselect_b32 s3, 0, s63
    s_bfe_u32 s100, s2, 0x10002
    s_lshl3_add_u32 s100, s100, s34
    s_mov_b32 s62, 0
    v_lshl_add_u32 v8, v3, 8, v92
    v_lshlrev_b32 v109, 8, v0
    v_mov_b32 v110, 0
    v_mov_b32 v108, 1
    s_mov_b64 s[36:37], s[56:57]
    s_mov_b64 s[52:53], s[58:59]
    s_mov_b32 s55, 0x20000
    s_lshl_b32 s63, s100, 12
    s_add_u32 s63, s63, 0x1000000
    s_add_u32 s56, s60, s63
    s_addc_u32 s57, s61, 0
    s_cmp_eq_u32 s35, 0
    s_cselect_b32 s58, 0x100, 0
    s_cselect_b32 s54, 0x100, 0
    s_mov_b32 s59, 0x20000
    buffer_store_dword v110, v109, s[56:59], 0 offen sc1
    s_add_u32 s3, s3, 1
    s_mov_b32 s65, s3
    s_lshl_b32 s64, s65, 3
    s_lshr_b32 s64, s101, s64
    s_lshl_b32 s42, s65, 14
    s_add_u32 s42, s42, s33
    s_and_b32 s65, s64, 7
    s_lshl_b32 s65, s65, 7
    s_bfe_u32 s66, s64, 0x30004
    s_lshl_b32 s66, s66, 7
    v_mad_u32_u24 v60, v112, s66, v88
    v_mad_u32_u24 v60, v113, s65, v60
    v_mad_u32_u24 v61, v112, s66, v89
    v_mad_u32_u24 v61, v113, s65, v61
    v_mad_u32_u24 v62, v113, s66, v90
    v_mad_u32_u24 v62, v112, s65, v62
    v_mad_u32_u24 v63, v113, s66, v91
    v_mad_u32_u24 v63, v112, s65, v63
    s_cmp_eq_u32 s3, 1
    s_cselect_b32 s65, 2, 1
    s_lshl_b32 s64, s65, 3
    s_lshr_b32 s64, s101, s64
    s_lshl_b32 s43, s65, 14
    s_add_u32 s43, s43, s33
    s_and_b32 s65, s64, 7
    s_lshl_b32 s65, s65, 7
    s_bfe_u32 s66, s64, 0x30004
    s_lshl_b32 s66, s66, 7
    v_mad_u32_u24 v64, v112, s66, v88
    v_mad_u32_u24 v64, v113, s65, v64
    v_mad_u32_u24 v65, v112, s66, v89
    v_mad_u32_u24 v65, v113, s65, v65
    v_mad_u32_u24 v66, v113, s66, v90
    v_mad_u32_u24 v66, v112, s65, v66
    v_mad_u32_u24 v67, v113, s66, v91
    v_mad_u32_u24 v67, v112, s65, v67
    s_cmp_eq_u32 s3, 3
    s_cselect_b32 s65, 2, 3
    s_lshl_b32 s64, s65, 3
    s_lshr_b32 s64, s101, s64
    s_lshl_b32 s44, s65, 14
    s_add_u32 s44, s44, s33
    s_and_b32 s65, s64, 7
    s_lshl_b32 s65, s65, 7
    s_bfe_u32 s66, s64, 0x30004
    s_lshl_b32 s66, s66, 7
    v_mad_u32_u24 v68, v112, s66, v88
    v_mad_u32_u24 v68, v113, s65, v68
    v_mad_u32_u24 v69, v112, s66, v89
    v_mad_u32_u24 v69, v113, s65, v69
    v_mad_u32_u24 v70, v113, s66, v90
    v_mad_u32_u24 v70, v112, s65, v70
    v_mad_u32_u24 v71, v113, s66, v91
    v_mad_u32_u24 v71, v112, s65, v71
    s_lshl_b32 s65, s34, 3
    s_lshr_b32 s63, s35, 1
    s_add_u32 s65, s65, s63
    s_lshl_b32 s65, s65, 19
    s_add_u32 s8, s8, s65
    s_addc_u32 s9, s9, 0
    s_mov_b32 s10, 0x80000
    s_mov_b32 s11, 0x20000
    s_add_u32 s12, s12, s65
    s_addc_u32 s13, s13, 0
    s_mov_b32 s14, 0x80000
    s_mov_b32 s15, 0x20000
    s_lshl_b32 s65, s35, 18
    s_add_u32 s20, s20, s65
    s_addc_u32 s21, s21, 0
    s_mov_b32 s22, 0x40000
    s_mov_b32 s23, 0x20000
    s_lshl_b32 s65, s100, 20
    s_add_u32 s24, s60, s65
    s_addc_u32 s25, s61, 0
    s_mov_b32 s26, 0x100000
    s_mov_b32 s27, 0x20000
    s_lshl_b32 s40, s100, 4
    s_movk_i32 s58, 0x100
    v_xor_b32 v9, 64, v8
    v_xor_b32 v10, 128, v8
    v_xor_b32 v11, 192, v8
    v_lshlrev_b32 v6, 1, v3
    v_xor_b32 v6, v6, v4
    v_lshlrev_b32 v6, 4, v6
    v_lshl_add_u32 v12, v3, 8, v6
    v_xor_b32 v13, 128, v12
    v_lshlrev_b32 v14, 4, v2
    v_lshl_add_u32 v16, v4, 8, v92
    v_add_u32 v16, 32768, v16
    v_xor_b32 v17, 64, v16
    v_xor_b32 v18, 128, v16
    v_xor_b32 v19, 192, v16
    v_lshrrev_b32 v5, 2, v2
    v_and_b32 v7, 3, v2
    v_lshlrev_b32 v7, 3, v7
    v_bfe_u32 v6, v2, 3, 2
    v_lshl_add_u32 v6, v6, 5, v7
    v_lshl_add_u32 v28, v5, 7, v6
    v_add_u32 v28, s33, v28
    v_xor_b32 v29, 32, v28
    v_xor_b32 v30, 64, v28
    v_xor_b32 v31, 96, v28
    v_add_u32 v32, 0x20000, v28
    v_add_u32 v33, 0x20000, v29
    v_add_u32 v34, 0x20000, v30
    v_add_u32 v35, 0x20000, v31
    s_mov_b32 s38, 0
    s_mov_b32 s30, 0
    s_mov_b32 s39, 0
    s_bitcmp1_b32 s28, 0
    s_cselect_b32 s63, 0x41000, 0
    s_xor_b32 s39, s39, s63
    s_bitcmp1_b32 s28, 1
    s_cselect_b32 s63, 0x2000, 0
    s_xor_b32 s39, s39, s63
    s_add_u32 m0, s42, 32768
    s_nop 0
    buffer_load_dwordx4 v60, s[4:7], 0 offen offset:0 lds
    buffer_load_dwordx4 v61, s[4:7], 0 offen offset:1024 lds
    buffer_load_dwordx4 v62, s[4:7], 0 offen offset:2048 lds
    buffer_load_dwordx4 v63, s[4:7], 0 offen offset:3072 lds
    s_add_u32 m0, s33, 131072
    s_nop 0
    buffer_load_dwordx4 v36, s[16:19], s67 offen offset:0 lds
    buffer_load_dwordx4 v37, s[16:19], s67 offen offset:1024 lds
    buffer_load_dwordx4 v38, s[16:19], s67 offen offset:2048 lds
    buffer_load_dwordx4 v39, s[16:19], s67 offen offset:3072 lds
    s_xor_b32 s67, s67, 0x40000
    s_add_u32 m0, s33, 147456
    s_nop 0
    buffer_load_dwordx4 v36, s[16:19], s67 offen offset:0 lds
    buffer_load_dwordx4 v37, s[16:19], s67 offen offset:1024 lds
    buffer_load_dwordx4 v38, s[16:19], s67 offen offset:2048 lds
    buffer_load_dwordx4 v39, s[16:19], s67 offen offset:3072 lds
    s_bfe_u32 s67, s101, 0x30008
    s_lshl_b32 s67, s67, 19
    s_waitcnt vmcnt(13)
    s_barrier
    ds_read_b64_tr_b16 a[64:65], v28 offset:0
    ds_read_b64_tr_b16 a[66:67], v28 offset:2048
    ds_read_b128 a[128:131], v16 offset:0
    ds_read_b128 a[132:135], v16 offset:4096
    ds_read_b128 a[136:139], v16 offset:8192
    ds_read_b128 a[140:143], v16 offset:12288
    ds_read_b64_tr_b16 a[68:69], v29 offset:0
    ds_read_b64_tr_b16 a[70:71], v29 offset:2048
    ds_read_b64_tr_b16 a[72:73], v30 offset:0
    ds_read_b64_tr_b16 a[74:75], v30 offset:2048
    ds_read_b64_tr_b16 a[76:77], v31 offset:0
    ds_read_b64_tr_b16 a[78:79], v31 offset:2048
    ds_read_b64_tr_b16 a[80:81], v28 offset:16384
    ds_read_b64_tr_b16 a[82:83], v28 offset:18432
    ds_read_b128 a[144:147], v17 offset:0
    ds_read_b128 a[148:151], v17 offset:4096
    ds_read_b128 a[152:155], v17 offset:8192
    ds_read_b128 a[156:159], v17 offset:12288
    ds_read_b64_tr_b16 a[84:85], v29 offset:16384
    ds_read_b64_tr_b16 a[86:87], v29 offset:18432
    ds_read_b64_tr_b16 a[88:89], v30 offset:16384
    ds_read_b64_tr_b16 a[90:91], v30 offset:18432
    ds_read_b64_tr_b16 a[92:93], v31 offset:16384
    ds_read_b64_tr_b16 a[94:95], v31 offset:18432
    s_waitcnt lgkmcnt(15)
    v_mfma_f32_16x16x32_bf16 v[128:131], a[64:67], a[128:131], 0
    s_waitcnt lgkmcnt(9)
    s_waitcnt vmcnt(4)
    ds_read_b64_tr_b16 a[96:97], v32 offset:0
    v_mfma_f32_16x16x32_bf16 v[128:131], a[80:83], a[144:147], v[128:131]
    ds_read_b64_tr_b16 a[98:99], v32 offset:2048
    v_mfma_f32_16x16x32_bf16 v[132:135], a[64:67], a[132:135], 0
    s_waitcnt lgkmcnt(10)
    v_mfma_f32_16x16x32_bf16 v[132:135], a[80:83], a[148:151], v[132:135]
    s_waitcnt lgkmcnt(2)
    ds_read_b128 a[160:163], v18 offset:0
    v_mfma_f32_16x16x32_bf16 v[136:139], a[64:67], a[136:139], 0
    s_add_u32 m0, s43, 32768
    ds_read_b128 a[164:167], v18 offset:4096
    buffer_load_dwordx4 v64, s[4:7], 0 offen offset:0 lds
    v_mfma_f32_16x16x32_bf16 v[136:139], a[80:83], a[152:155], v[136:139]
    ds_read_b128 a[168:171], v18 offset:8192
    buffer_load_dwordx4 v65, s[4:7], 0 offen offset:1024 lds
    v_mfma_f32_16x16x32_bf16 v[140:143], a[64:67], a[140:143], 0
    ds_read_b128 a[172:175], v18 offset:12288
    buffer_load_dwordx4 v66, s[4:7], 0 offen offset:2048 lds
    v_mfma_f32_16x16x32_bf16 v[140:143], a[80:83], a[156:159], v[140:143]
    ds_read_b64_tr_b16 a[100:101], v33 offset:0
    buffer_load_dwordx4 v67, s[4:7], 0 offen offset:3072 lds
    v_mfma_f32_16x16x32_bf16 v[144:147], a[68:71], a[128:131], 0
    s_add_u32 m0, s33, 0
    ds_read_b64_tr_b16 a[102:103], v33 offset:2048
    buffer_load_dwordx4 v36, s[16:19], s67 offen offset:0 lds
    v_mfma_f32_16x16x32_bf16 v[144:147], a[84:87], a[144:147], v[144:147]
    ds_read_b64_tr_b16 a[104:105], v34 offset:0
    buffer_load_dwordx4 v37, s[16:19], s67 offen offset:1024 lds
    v_mfma_f32_16x16x32_bf16 v[148:151], a[68:71], a[132:135], 0
    ds_read_b64_tr_b16 a[106:107], v34 offset:2048
    buffer_load_dwordx4 v38, s[16:19], s67 offen offset:2048 lds
    v_mfma_f32_16x16x32_bf16 v[148:151], a[84:87], a[148:151], v[148:151]
    ds_read_b64_tr_b16 a[108:109], v35 offset:0
    buffer_load_dwordx4 v39, s[16:19], s67 offen offset:3072 lds
    s_xor_b32 s67, s67, 0x40000
    v_mfma_f32_16x16x32_bf16 v[152:155], a[68:71], a[136:139], 0
    s_add_u32 m0, s33, 16384
    ds_read_b64_tr_b16 a[110:111], v35 offset:2048
    buffer_load_dwordx4 v36, s[16:19], s67 offen offset:0 lds
    v_mfma_f32_16x16x32_bf16 v[152:155], a[84:87], a[152:155], v[152:155]
    buffer_load_dwordx4 v37, s[16:19], s67 offen offset:1024 lds
    v_mfma_f32_16x16x32_bf16 v[156:159], a[68:71], a[140:143], 0
    buffer_load_dwordx4 v38, s[16:19], s67 offen offset:2048 lds
    v_mfma_f32_16x16x32_bf16 v[156:159], a[84:87], a[156:159], v[156:159]
    buffer_load_dwordx4 v39, s[16:19], s67 offen offset:3072 lds
    s_bfe_u32 s67, s101, 0x3000c
    s_lshl_b32 s67, s67, 19
    v_mfma_f32_16x16x32_bf16 v[160:163], a[72:75], a[128:131], 0
    s_waitcnt vmcnt(12)
    ds_read_b64_tr_b16 a[112:113], v32 offset:16384
    v_mfma_f32_16x16x32_bf16 v[160:163], a[88:91], a[144:147], v[160:163]
    ds_read_b64_tr_b16 a[114:115], v32 offset:18432
    v_mfma_f32_16x16x32_bf16 v[164:167], a[72:75], a[132:135], 0
    v_mfma_f32_16x16x32_bf16 v[164:167], a[88:91], a[148:151], v[164:167]
    s_waitcnt lgkmcnt(2)
    ds_read_b128 a[176:179], v19 offset:0
    v_mfma_f32_16x16x32_bf16 v[168:171], a[72:75], a[136:139], 0
    s_add_u32 m0, s33, 131072
    ds_read_b128 a[180:183], v19 offset:4096
    buffer_load_dwordx4 v36, s[16:19], s67 offen offset:0 lds
    v_mfma_f32_16x16x32_bf16 v[168:171], a[88:91], a[152:155], v[168:171]
    ds_read_b128 a[184:187], v19 offset:8192
    v_mfma_f32_16x16x32_bf16 v[172:175], a[72:75], a[140:143], 0
    ds_read_b128 a[188:191], v19 offset:12288
    v_mfma_f32_16x16x32_bf16 v[172:175], a[88:91], a[156:159], v[172:175]
    ds_read_b64_tr_b16 a[116:117], v33 offset:16384
    buffer_load_dwordx4 v37, s[16:19], s67 offen offset:1024 lds
    v_mfma_f32_16x16x32_bf16 v[176:179], a[76:79], a[128:131], 0
    ds_read_b64_tr_b16 a[118:119], v33 offset:18432
    v_mfma_f32_16x16x32_bf16 v[176:179], a[92:95], a[144:147], v[176:179]
    ds_read_b64_tr_b16 a[120:121], v34 offset:16384
    v_mfma_f32_16x16x32_bf16 v[180:183], a[76:79], a[132:135], 0
    ds_read_b64_tr_b16 a[122:123], v34 offset:18432
    buffer_load_dwordx4 v38, s[16:19], s67 offen offset:2048 lds
    v_mfma_f32_16x16x32_bf16 v[180:183], a[92:95], a[148:151], v[180:183]
    ds_read_b64_tr_b16 a[124:125], v35 offset:16384
    v_mfma_f32_16x16x32_bf16 v[184:187], a[76:79], a[136:139], 0
    ds_read_b64_tr_b16 a[126:127], v35 offset:18432
    v_mfma_f32_16x16x32_bf16 v[184:187], a[92:95], a[152:155], v[184:187]
    buffer_load_dwordx4 v39, s[16:19], s67 offen offset:3072 lds
    s_xor_b32 s67, s67, 0x40000
    v_mfma_f32_16x16x32_bf16 v[188:191], a[76:79], a[140:143], 0
    v_mfma_f32_16x16x32_bf16 v[188:191], a[92:95], a[156:159], v[188:191]
    v_mfma_f32_16x16x32_bf16 v[128:131], a[96:99], a[160:163], v[128:131]
    s_waitcnt lgkmcnt(1)
    s_waitcnt vmcnt(8)
    ds_read_b64_tr_b16 a[64:65], v28 offset:0
    v_mfma_f32_16x16x32_bf16 v[128:131], a[112:115], a[176:179], v[128:131]
    s_barrier
    ds_read_b64_tr_b16 a[66:67], v28 offset:2048
    v_mfma_f32_16x16x32_bf16 v[132:135], a[96:99], a[164:167], v[132:135]
    v_mfma_f32_16x16x32_bf16 v[132:135], a[112:115], a[180:183], v[132:135]
    s_waitcnt lgkmcnt(2)
    ds_read_b128 a[128:131], v16 offset:16384
    v_mfma_f32_16x16x32_bf16 v[136:139], a[96:99], a[168:171], v[136:139]
    s_add_u32 m0, s33, 147456
    ds_read_b128 a[132:135], v16 offset:20480
    buffer_load_dwordx4 v36, s[16:19], s67 offen offset:0 lds
    v_mfma_f32_16x16x32_bf16 v[136:139], a[112:115], a[184:187], v[136:139]
    ds_read_b128 a[136:139], v16 offset:24576
    v_mfma_f32_16x16x32_bf16 v[140:143], a[96:99], a[172:175], v[140:143]
    ds_read_b128 a[140:143], v16 offset:28672
    v_mfma_f32_16x16x32_bf16 v[140:143], a[112:115], a[188:191], v[140:143]
    ds_read_b64_tr_b16 a[68:69], v29 offset:0
    buffer_load_dwordx4 v37, s[16:19], s67 offen offset:1024 lds
    v_mfma_f32_16x16x32_bf16 v[144:147], a[100:103], a[160:163], v[144:147]
    ds_read_b64_tr_b16 a[70:71], v29 offset:2048
    v_mfma_f32_16x16x32_bf16 v[144:147], a[116:119], a[176:179], v[144:147]
    ds_read_b64_tr_b16 a[72:73], v30 offset:0
    v_mfma_f32_16x16x32_bf16 v[148:151], a[100:103], a[164:167], v[148:151]
    ds_read_b64_tr_b16 a[74:75], v30 offset:2048
    buffer_load_dwordx4 v38, s[16:19], s67 offen offset:2048 lds
    v_mfma_f32_16x16x32_bf16 v[148:151], a[116:119], a[180:183], v[148:151]
    ds_read_b64_tr_b16 a[76:77], v31 offset:0
    v_mfma_f32_16x16x32_bf16 v[152:155], a[100:103], a[168:171], v[152:155]
    ds_read_b64_tr_b16 a[78:79], v31 offset:2048
    v_mfma_f32_16x16x32_bf16 v[152:155], a[116:119], a[184:187], v[152:155]
    buffer_load_dwordx4 v39, s[16:19], s67 offen offset:3072 lds
    s_bfe_u32 s67, s101, 0x30010
    s_lshl_b32 s67, s67, 19
    v_mfma_f32_16x16x32_bf16 v[156:159], a[100:103], a[172:175], v[156:159]
    v_mfma_f32_16x16x32_bf16 v[156:159], a[116:119], a[188:191], v[156:159]
    v_mfma_f32_16x16x32_bf16 v[160:163], a[104:107], a[160:163], v[160:163]
    s_waitcnt vmcnt(8)
    ds_read_b64_tr_b16 a[80:81], v28 offset:16384
    v_mfma_f32_16x16x32_bf16 v[160:163], a[120:123], a[176:179], v[160:163]
    ds_read_b64_tr_b16 a[82:83], v28 offset:18432
    v_mfma_f32_16x16x32_bf16 v[164:167], a[104:107], a[164:167], v[164:167]
    v_mfma_f32_16x16x32_bf16 v[164:167], a[120:123], a[180:183], v[164:167]
    s_waitcnt lgkmcnt(2)
    ds_read_b128 a[144:147], v17 offset:16384
    v_mfma_f32_16x16x32_bf16 v[168:171], a[104:107], a[168:171], v[168:171]
    s_add_u32 m0, s33, 0
    ds_read_b128 a[148:151], v17 offset:20480
    buffer_load_dwordx4 v36, s[16:19], s67 offen offset:0 lds
    v_mfma_f32_16x16x32_bf16 v[168:171], a[120:123], a[184:187], v[168:171]
    ds_read_b128 a[152:155], v17 offset:24576
    buffer_load_dwordx4 v37, s[16:19], s67 offen offset:1024 lds
    v_mfma_f32_16x16x32_bf16 v[172:175], a[104:107], a[172:175], v[172:175]
    ds_read_b128 a[156:159], v17 offset:28672
    v_mfma_f32_16x16x32_bf16 v[172:175], a[120:123], a[188:191], v[172:175]
    ds_read_b64_tr_b16 a[84:85], v29 offset:16384
    buffer_load_dwordx4 v38, s[16:19], s67 offen offset:2048 lds
    v_mfma_f32_16x16x32_bf16 v[176:179], a[108:111], a[160:163], v[176:179]
    ds_read_b64_tr_b16 a[86:87], v29 offset:18432
    buffer_load_dwordx4 v39, s[16:19], s67 offen offset:3072 lds
    s_xor_b32 s67, s67, 0x40000
    v_mfma_f32_16x16x32_bf16 v[176:179], a[124:127], a[176:179], v[176:179]
    ds_read_b64_tr_b16 a[88:89], v30 offset:16384
    v_mfma_f32_16x16x32_bf16 v[180:183], a[108:111], a[164:167], v[180:183]
    s_add_u32 m0, s44, 32768
    ds_read_b64_tr_b16 a[90:91], v30 offset:18432
    buffer_load_dwordx4 v68, s[4:7], 0 offen offset:0 lds
    v_mfma_f32_16x16x32_bf16 v[180:183], a[124:127], a[180:183], v[180:183]
    ds_read_b64_tr_b16 a[92:93], v31 offset:16384
    buffer_load_dwordx4 v69, s[4:7], 0 offen offset:1024 lds
    v_mfma_f32_16x16x32_bf16 v[184:187], a[108:111], a[168:171], v[184:187]
    ds_read_b64_tr_b16 a[94:95], v31 offset:18432
    v_mfma_f32_16x16x32_bf16 v[184:187], a[124:127], a[184:187], v[184:187]
    buffer_load_dwordx4 v70, s[4:7], 0 offen offset:2048 lds
    v_mfma_f32_16x16x32_bf16 v[188:191], a[108:111], a[172:175], v[188:191]
    buffer_load_dwordx4 v71, s[4:7], 0 offen offset:3072 lds
    v_mfma_f32_16x16x32_bf16 v[188:191], a[124:127], a[188:191], v[188:191]
    v_mfma_f32_16x16x32_bf16 v[128:131], a[64:67], a[128:131], v[128:131]
    s_waitcnt lgkmcnt(1)
    s_waitcnt vmcnt(12)
    ds_read_b64_tr_b16 a[96:97], v32 offset:0
    v_mfma_f32_16x16x32_bf16 v[128:131], a[80:83], a[144:147], v[128:131]
    ds_read_b64_tr_b16 a[98:99], v32 offset:2048
    v_and_b32 v6, 7, v5
    v_mfma_f32_16x16x32_bf16 v[132:135], a[64:67], a[132:135], v[132:135]
    v_mfma_f32_16x16x32_bf16 v[132:135], a[80:83], a[148:151], v[132:135]
    s_waitcnt lgkmcnt(2)
    ds_read_b128 a[160:163], v18 offset:16384
    v_lshl_add_u32 v6, v6, 5, v7
    v_mfma_f32_16x16x32_bf16 v[136:139], a[64:67], a[136:139], v[136:139]
    s_add_u32 m0, s33, 16384
    ds_read_b128 a[164:167], v18 offset:20480
    buffer_load_dwordx4 v36, s[16:19], s67 offen offset:0 lds
    v_mfma_f32_16x16x32_bf16 v[136:139], a[80:83], a[152:155], v[136:139]
    ds_read_b128 a[168:171], v18 offset:24576
    v_lshl_add_u32 v20, v5, 8, v6
    v_mfma_f32_16x16x32_bf16 v[140:143], a[64:67], a[140:143], v[140:143]
    ds_read_b128 a[172:175], v18 offset:28672
    v_mfma_f32_16x16x32_bf16 v[140:143], a[80:83], a[156:159], v[140:143]
    ds_read_b64_tr_b16 a[100:101], v33 offset:0
    buffer_load_dwordx4 v37, s[16:19], s67 offen offset:1024 lds
    v_mfma_f32_16x16x32_bf16 v[144:147], a[68:71], a[128:131], v[144:147]
    ds_read_b64_tr_b16 a[102:103], v33 offset:2048
    v_mfma_f32_16x16x32_bf16 v[144:147], a[84:87], a[144:147], v[144:147]
    ds_read_b64_tr_b16 a[104:105], v34 offset:0
    v_and_b32 v6, 1, v1
    v_mfma_f32_16x16x32_bf16 v[148:151], a[68:71], a[132:135], v[148:151]
    ds_read_b64_tr_b16 a[106:107], v34 offset:2048
    buffer_load_dwordx4 v38, s[16:19], s67 offen offset:2048 lds
    v_mfma_f32_16x16x32_bf16 v[148:151], a[84:87], a[148:151], v[148:151]
    ds_read_b64_tr_b16 a[108:109], v35 offset:0
    v_lshl_add_u32 v20, v6, 13, v20
    v_mfma_f32_16x16x32_bf16 v[152:155], a[68:71], a[136:139], v[152:155]
    ds_read_b64_tr_b16 a[110:111], v35 offset:2048
    v_mfma_f32_16x16x32_bf16 v[152:155], a[84:87], a[152:155], v[152:155]
    buffer_load_dwordx4 v39, s[16:19], s67 offen offset:3072 lds
    s_bfe_u32 s67, s101, 0x30014
    s_lshl_b32 s67, s67, 19
    v_mfma_f32_16x16x32_bf16 v[156:159], a[68:71], a[140:143], v[156:159]
    v_mfma_f32_16x16x32_bf16 v[156:159], a[84:87], a[156:159], v[156:159]
    v_add_u32 v20, 98304, v20
    v_mfma_f32_16x16x32_bf16 v[160:163], a[72:75], a[128:131], v[160:163]
    s_waitcnt vmcnt(12)
    ds_read_b64_tr_b16 a[112:113], v32 offset:16384
    v_mfma_f32_16x16x32_bf16 v[160:163], a[88:91], a[144:147], v[160:163]
    ds_read_b64_tr_b16 a[114:115], v32 offset:18432
    v_xor_b32 v21, 32, v20
    v_mfma_f32_16x16x32_bf16 v[164:167], a[72:75], a[132:135], v[164:167]
    v_mfma_f32_16x16x32_bf16 v[164:167], a[88:91], a[148:151], v[164:167]
    s_waitcnt lgkmcnt(2)
    ds_read_b128 a[176:179], v19 offset:16384
    v_xor_b32 v22, 64, v20
    v_mfma_f32_16x16x32_bf16 v[168:171], a[72:75], a[136:139], v[168:171]
    s_add_u32 m0, s33, 131072
    ds_read_b128 a[180:183], v19 offset:20480
    v_mfma_f32_16x16x32_bf16 v[168:171], a[88:91], a[152:155], v[168:171]
    ds_read_b128 a[184:187], v19 offset:24576
    buffer_load_dwordx4 v36, s[16:19], s67 offen offset:0 lds
    v_mfma_f32_16x16x32_bf16 v[172:175], a[72:75], a[140:143], v[172:175]
    ds_read_b128 a[188:191], v19 offset:28672
    v_mfma_f32_16x16x32_bf16 v[172:175], a[88:91], a[156:159], v[172:175]
    ds_read_b64_tr_b16 a[116:117], v33 offset:16384
    v_xor_b32 v23, 96, v20
    v_mfma_f32_16x16x32_bf16 v[176:179], a[76:79], a[128:131], v[176:179]
    ds_read_b64_tr_b16 a[118:119], v33 offset:18432
    buffer_load_dwordx4 v37, s[16:19], s67 offen offset:1024 lds
    v_mfma_f32_16x16x32_bf16 v[176:179], a[92:95], a[144:147], v[176:179]
    ds_read_b64_tr_b16 a[120:121], v34 offset:16384
    v_xor_b32 v24, 128, v20
    v_mfma_f32_16x16x32_bf16 v[180:183], a[76:79], a[132:135], v[180:183]
    ds_read_b64_tr_b16 a[122:123], v34 offset:18432
    v_mfma_f32_16x16x32_bf16 v[180:183], a[92:95], a[148:151], v[180:183]
    ds_read_b64_tr_b16 a[124:125], v35 offset:16384
    buffer_load_dwordx4 v38, s[16:19], s67 offen offset:2048 lds
    v_mfma_f32_16x16x32_bf16 v[184:187], a[76:79], a[136:139], v[184:187]
    ds_read_b64_tr_b16 a[126:127], v35 offset:18432
    v_mfma_f32_16x16x32_bf16 v[184:187], a[92:95], a[152:155], v[184:187]
    v_xor_b32 v25, 160, v20
    v_mfma_f32_16x16x32_bf16 v[188:191], a[76:79], a[140:143], v[188:191]
    buffer_load_dwordx4 v39, s[16:19], s67 offen offset:3072 lds
    v_mfma_f32_16x16x32_bf16 v[188:191], a[92:95], a[156:159], v[188:191]
    s_xor_b32 s67, s67, 0x40000
    v_xor_b32 v26, 192, v20
    v_mfma_f32_16x16x32_bf16 v[128:131], a[96:99], a[160:163], v[128:131]
    s_waitcnt lgkmcnt(1)
    s_waitcnt vmcnt(8)
    ds_read_b64_tr_b16 a[64:65], v28 offset:0
    v_mfma_f32_16x16x32_bf16 v[128:131], a[112:115], a[176:179], v[128:131]
    s_barrier
    ds_read_b64_tr_b16 a[66:67], v28 offset:2048
    v_xor_b32 v27, 224, v20
    v_mfma_f32_16x16x32_bf16 v[132:135], a[96:99], a[164:167], v[132:135]
    v_mfma_f32_16x16x32_bf16 v[132:135], a[112:115], a[180:183], v[132:135]
    s_waitcnt lgkmcnt(2)
    ds_read_b128 a[128:131], v16 offset:32768
    v_and_b32 v6, 3, v2
    v_mfma_f32_16x16x32_bf16 v[136:139], a[96:99], a[168:171], v[136:139]
    s_add_u32 m0, s33, 147456
    ds_read_b128 a[132:135], v16 offset:36864
    v_mfma_f32_16x16x32_bf16 v[136:139], a[112:115], a[184:187], v[136:139]
    ds_read_b128 a[136:139], v16 offset:40960
    buffer_load_dwordx4 v36, s[16:19], s67 offen offset:0 lds
    v_mfma_f32_16x16x32_bf16 v[140:143], a[96:99], a[172:175], v[140:143]
    ds_read_b128 a[140:143], v16 offset:45056
    v_mfma_f32_16x16x32_bf16 v[140:143], a[112:115], a[188:191], v[140:143]
    ds_read_b64_tr_b16 a[68:69], v29 offset:0
    v_cmp_eq_u32 vcc, 0, v6
    v_mfma_f32_16x16x32_bf16 v[144:147], a[100:103], a[160:163], v[144:147]
    ds_read_b64_tr_b16 a[70:71], v29 offset:2048
    buffer_load_dwordx4 v37, s[16:19], s67 offen offset:1024 lds
    v_mfma_f32_16x16x32_bf16 v[144:147], a[116:119], a[176:179], v[144:147]
    ds_read_b64_tr_b16 a[72:73], v30 offset:0
    v_mov_b32 v6, 0x3f803f80
    v_mfma_f32_16x16x32_bf16 v[148:151], a[100:103], a[164:167], v[148:151]
    ds_read_b64_tr_b16 a[74:75], v30 offset:2048
    v_mfma_f32_16x16x32_bf16 v[148:151], a[116:119], a[180:183], v[148:151]
    ds_read_b64_tr_b16 a[76:77], v31 offset:0
    buffer_load_dwordx4 v38, s[16:19], s67 offen offset:2048 lds
    v_mfma_f32_16x16x32_bf16 v[152:155], a[100:103], a[168:171], v[152:155]
    ds_read_b64_tr_b16 a[78:79], v31 offset:2048
    v_mfma_f32_16x16x32_bf16 v[152:155], a[116:119], a[184:187], v[152:155]
    v_cndmask_b32 v120, 0, v6, vcc
    v_mfma_f32_16x16x32_bf16 v[156:159], a[100:103], a[172:175], v[156:159]
    buffer_load_dwordx4 v39, s[16:19], s67 offen offset:3072 lds
    v_mfma_f32_16x16x32_bf16 v[156:159], a[116:119], a[188:191], v[156:159]
    s_bfe_u32 s67, s101, 0x30018
    s_lshl_b32 s67, s67, 19
    v_cndmask_b32 v121, 0, v6, vcc
    v_mfma_f32_16x16x32_bf16 v[160:163], a[104:107], a[160:163], v[160:163]
    s_waitcnt vmcnt(8)
    ds_read_b64_tr_b16 a[80:81], v28 offset:16384
    v_mfma_f32_16x16x32_bf16 v[160:163], a[120:123], a[176:179], v[160:163]
    ds_read_b64_tr_b16 a[82:83], v28 offset:18432
    v_cndmask_b32 v122, 0, v6, vcc
    v_mfma_f32_16x16x32_bf16 v[164:167], a[104:107], a[164:167], v[164:167]
    v_mfma_f32_16x16x32_bf16 v[164:167], a[120:123], a[180:183], v[164:167]
    s_waitcnt lgkmcnt(2)
    ds_read_b128 a[144:147], v17 offset:32768
    v_cndmask_b32 v123, 0, v6, vcc
    v_mfma_f32_16x16x32_bf16 v[168:171], a[104:107], a[168:171], v[168:171]
    s_add_u32 m0, s33, 0
    ds_read_b128 a[148:151], v17 offset:36864
    v_mfma_f32_16x16x32_bf16 v[168:171], a[120:123], a[184:187], v[168:171]
    ds_read_b128 a[152:155], v17 offset:40960
    buffer_load_dwordx4 v36, s[16:19], s67 offen offset:0 lds
    v_mfma_f32_16x16x32_bf16 v[172:175], a[104:107], a[172:175], v[172:175]
    ds_read_b128 a[156:159], v17 offset:45056
    v_mfma_f32_16x16x32_bf16 v[172:175], a[120:123], a[188:191], v[172:175]
    ds_read_b64_tr_b16 a[84:85], v29 offset:16384
    v_lshrrev_b32 v96, 1, v3
    v_mfma_f32_16x16x32_bf16 v[176:179], a[108:111], a[160:163], v[176:179]
    ds_read_b64_tr_b16 a[86:87], v29 offset:18432
    buffer_load_dwordx4 v37, s[16:19], s67 offen offset:1024 lds
    v_mfma_f32_16x16x32_bf16 v[176:179], a[124:127], a[176:179], v[176:179]
    ds_read_b64_tr_b16 a[88:89], v30 offset:16384
    v_and_b32 v6, 1, v1
    v_mfma_f32_16x16x32_bf16 v[180:183], a[108:111], a[164:167], v[180:183]
    ds_read_b64_tr_b16 a[90:91], v30 offset:18432
    v_mfma_f32_16x16x32_bf16 v[180:183], a[124:127], a[180:183], v[180:183]
    ds_read_b64_tr_b16 a[92:93], v31 offset:16384
    buffer_load_dwordx4 v38, s[16:19], s67 offen offset:2048 lds
    v_mfma_f32_16x16x32_bf16 v[184:187], a[108:111], a[168:171], v[184:187]
    ds_read_b64_tr_b16 a[94:95], v31 offset:18432
    v_mfma_f32_16x16x32_bf16 v[184:187], a[124:127], a[184:187], v[184:187]
    v_lshl_add_u32 v96, v6, 3, v96
    v_mfma_f32_16x16x32_bf16 v[188:191], a[108:111], a[172:175], v[188:191]
    buffer_load_dwordx4 v39, s[16:19], s67 offen offset:3072 lds
    v_mfma_f32_16x16x32_bf16 v[188:191], a[124:127], a[188:191], v[188:191]
    s_xor_b32 s67, s67, 0x40000
    v_xor_b32 v96, v96, v4
    v_mfma_f32_16x16x32_bf16 v[128:131], a[64:67], a[128:131], v[128:131]
    s_waitcnt lgkmcnt(1)
    s_waitcnt vmcnt(8)
    ds_read_b64_tr_b16 a[96:97], v32 offset:0
    v_mfma_f32_16x16x32_bf16 v[128:131], a[80:83], a[144:147], v[128:131]
    ds_read_b64_tr_b16 a[98:99], v32 offset:2048
    v_lshlrev_b32 v96, 4, v96
    v_mfma_f32_16x16x32_bf16 v[132:135], a[64:67], a[132:135], v[132:135]
    v_mfma_f32_16x16x32_bf16 v[132:135], a[80:83], a[148:151], v[132:135]
    s_waitcnt lgkmcnt(2)
    ds_read_b128 a[160:163], v18 offset:32768
    v_lshl_add_u32 v96, v4, 8, v96
    v_mfma_f32_16x16x32_bf16 v[136:139], a[64:67], a[136:139], v[136:139]
    s_add_u32 m0, s33, 16384
    ds_read_b128 a[164:167], v18 offset:36864
    v_mfma_f32_16x16x32_bf16 v[136:139], a[80:83], a[152:155], v[136:139]
    ds_read_b128 a[168:171], v18 offset:40960
    buffer_load_dwordx4 v36, s[16:19], s67 offen offset:0 lds
    v_mfma_f32_16x16x32_bf16 v[140:143], a[64:67], a[140:143], v[140:143]
    ds_read_b128 a[172:175], v18 offset:45056
    v_mfma_f32_16x16x32_bf16 v[140:143], a[80:83], a[156:159], v[140:143]
    ds_read_b64_tr_b16 a[100:101], v33 offset:0
    v_and_b32 v6, 1, v3
    v_mfma_f32_16x16x32_bf16 v[144:147], a[68:71], a[128:131], v[144:147]
    ds_read_b64_tr_b16 a[102:103], v33 offset:2048
    buffer_load_dwordx4 v37, s[16:19], s67 offen offset:1024 lds
    v_mfma_f32_16x16x32_bf16 v[144:147], a[84:87], a[144:147], v[144:147]
    ds_read_b64_tr_b16 a[104:105], v34 offset:0
    v_lshl_add_u32 v96, v6, 3, v96
    v_mfma_f32_16x16x32_bf16 v[148:151], a[68:71], a[132:135], v[148:151]
    ds_read_b64_tr_b16 a[106:107], v34 offset:2048
    v_mfma_f32_16x16x32_bf16 v[148:151], a[84:87], a[148:151], v[148:151]
    ds_read_b64_tr_b16 a[108:109], v35 offset:0
    buffer_load_dwordx4 v38, s[16:19], s67 offen offset:2048 lds
    v_mfma_f32_16x16x32_bf16 v[152:155], a[68:71], a[136:139], v[152:155]
    ds_read_b64_tr_b16 a[110:111], v35 offset:2048
    v_mfma_f32_16x16x32_bf16 v[152:155], a[84:87], a[152:155], v[152:155]
    v_lshrrev_b32 v6, 1, v1
    v_mfma_f32_16x16x32_bf16 v[156:159], a[68:71], a[140:143], v[156:159]
    buffer_load_dwordx4 v39, s[16:19], s67 offen offset:3072 lds
    v_mfma_f32_16x16x32_bf16 v[156:159], a[84:87], a[156:159], v[156:159]
    s_bfe_u32 s67, s101, 0x3001c
    s_lshl_b32 s67, s67, 19
    v_lshl_add_u32 v96, v6, 14, v96
    v_mfma_f32_16x16x32_bf16 v[160:163], a[72:75], a[128:131], v[160:163]
    s_waitcnt vmcnt(8)
    ds_read_b64_tr_b16 a[112:113], v32 offset:16384
    v_mfma_f32_16x16x32_bf16 v[160:163], a[88:91], a[144:147], v[160:163]
    ds_read_b64_tr_b16 a[114:115], v32 offset:18432
    v_xor_b32 v97, 32, v96
    v_mfma_f32_16x16x32_bf16 v[164:167], a[72:75], a[132:135], v[164:167]
    v_mfma_f32_16x16x32_bf16 v[164:167], a[88:91], a[148:151], v[164:167]
    s_waitcnt lgkmcnt(2)
    ds_read_b128 a[176:179], v19 offset:32768
    v_xor_b32 v98, 64, v96
    v_mfma_f32_16x16x32_bf16 v[168:171], a[72:75], a[136:139], v[168:171]
    s_add_u32 m0, s33, 131072
    ds_read_b128 a[180:183], v19 offset:36864
    v_mfma_f32_16x16x32_bf16 v[168:171], a[88:91], a[152:155], v[168:171]
    ds_read_b128 a[184:187], v19 offset:40960
    buffer_load_dwordx4 v36, s[16:19], s67 offen offset:0 lds
    v_mfma_f32_16x16x32_bf16 v[172:175], a[72:75], a[140:143], v[172:175]
    ds_read_b128 a[188:191], v19 offset:45056
    v_mfma_f32_16x16x32_bf16 v[172:175], a[88:91], a[156:159], v[172:175]
    ds_read_b64_tr_b16 a[116:117], v33 offset:16384
    v_xor_b32 v99, 96, v96
    v_mfma_f32_16x16x32_bf16 v[176:179], a[76:79], a[128:131], v[176:179]
    ds_read_b64_tr_b16 a[118:119], v33 offset:18432
    buffer_load_dwordx4 v37, s[16:19], s67 offen offset:1024 lds
    v_mfma_f32_16x16x32_bf16 v[176:179], a[92:95], a[144:147], v[176:179]
    ds_read_b64_tr_b16 a[120:121], v34 offset:16384
    v_lshlrev_b32 v6, 14, v6
    v_mfma_f32_16x16x32_bf16 v[180:183], a[76:79], a[132:135], v[180:183]
    ds_read_b64_tr_b16 a[122:123], v34 offset:18432
    v_mfma_f32_16x16x32_bf16 v[180:183], a[92:95], a[148:151], v[180:183]
    ds_read_b64_tr_b16 a[124:125], v35 offset:16384
    buffer_load_dwordx4 v38, s[16:19], s67 offen offset:2048 lds
    v_mfma_f32_16x16x32_bf16 v[184:187], a[76:79], a[136:139], v[184:187]
    ds_read_b64_tr_b16 a[126:127], v35 offset:18432
    v_mfma_f32_16x16x32_bf16 v[184:187], a[92:95], a[152:155], v[184:187]
    v_and_b32 v100, 1, v1
    v_mfma_f32_16x16x32_bf16 v[188:191], a[76:79], a[140:143], v[188:191]
    buffer_load_dwordx4 v39, s[16:19], s67 offen offset:3072 lds
    v_mfma_f32_16x16x32_bf16 v[188:191], a[92:95], a[156:159], v[188:191]
    s_xor_b32 s67, s67, 0x40000
    v_lshl_add_u32 v6, v100, 12, v6
    v_mfma_f32_16x16x32_bf16 v[128:131], a[96:99], a[160:163], v[128:131]
    s_waitcnt lgkmcnt(1)
    s_waitcnt vmcnt(8)
    ds_read_b64_tr_b16 a[64:65], v28 offset:0
    v_mfma_f32_16x16x32_bf16 v[128:131], a[112:115], a[176:179], v[128:131]
    s_barrier
    ds_read_b64_tr_b16 a[66:67], v28 offset:2048
    v_subrev_u32 v6, 32768, v6
    v_mfma_f32_16x16x32_bf16 v[132:135], a[96:99], a[164:167], v[132:135]
    v_mfma_f32_16x16x32_bf16 v[132:135], a[112:115], a[180:183], v[132:135]
    s_waitcnt lgkmcnt(2)
    ds_read_b128 a[128:131], v16 offset:49152
    v_add_u32 v104, v6, v16
    v_mfma_f32_16x16x32_bf16 v[136:139], a[96:99], a[168:171], v[136:139]
    s_add_u32 m0, s33, 147456
    ds_read_b128 a[132:135], v16 offset:53248
    v_mfma_f32_16x16x32_bf16 v[136:139], a[112:115], a[184:187], v[136:139]
    ds_read_b128 a[136:139], v16 offset:57344
    buffer_load_dwordx4 v36, s[16:19], s67 offen offset:0 lds
    v_mfma_f32_16x16x32_bf16 v[140:143], a[96:99], a[172:175], v[140:143]
    ds_read_b128 a[140:143], v16 offset:61440
    v_mfma_f32_16x16x32_bf16 v[140:143], a[112:115], a[188:191], v[140:143]
    ds_read_b64_tr_b16 a[68:69], v29 offset:0
    v_add_u32 v105, v6, v17
    v_mfma_f32_16x16x32_bf16 v[144:147], a[100:103], a[160:163], v[144:147]
    ds_read_b64_tr_b16 a[70:71], v29 offset:2048
    buffer_load_dwordx4 v37, s[16:19], s67 offen offset:1024 lds
    v_mfma_f32_16x16x32_bf16 v[144:147], a[116:119], a[176:179], v[144:147]
    ds_read_b64_tr_b16 a[72:73], v30 offset:0
    v_add_u32 v106, v6, v18
    v_mfma_f32_16x16x32_bf16 v[148:151], a[100:103], a[164:167], v[148:151]
    ds_read_b64_tr_b16 a[74:75], v30 offset:2048
    v_mfma_f32_16x16x32_bf16 v[148:151], a[116:119], a[180:183], v[148:151]
    ds_read_b64_tr_b16 a[76:77], v31 offset:0
    buffer_load_dwordx4 v38, s[16:19], s67 offen offset:2048 lds
    v_mfma_f32_16x16x32_bf16 v[152:155], a[100:103], a[168:171], v[152:155]
    ds_read_b64_tr_b16 a[78:79], v31 offset:2048
    v_mfma_f32_16x16x32_bf16 v[152:155], a[116:119], a[184:187], v[152:155]
    v_add_u32 v107, v6, v19
    v_mfma_f32_16x16x32_bf16 v[156:159], a[100:103], a[172:175], v[156:159]
    buffer_load_dwordx4 v39, s[16:19], s67 offen offset:3072 lds
    v_mfma_f32_16x16x32_bf16 v[156:159], a[116:119], a[188:191], v[156:159]
    v_xor_b32 v100, 0x1000, v104
    v_mfma_f32_16x16x32_bf16 v[160:163], a[104:107], a[160:163], v[160:163]
    s_waitcnt vmcnt(8)
    ds_read_b64_tr_b16 a[80:81], v28 offset:16384
    v_mfma_f32_16x16x32_bf16 v[160:163], a[120:123], a[176:179], v[160:163]
    ds_read_b64_tr_b16 a[82:83], v28 offset:18432
    v_xor_b32 v101, 0x1000, v105
    v_mfma_f32_16x16x32_bf16 v[164:167], a[104:107], a[164:167], v[164:167]
    v_mfma_f32_16x16x32_bf16 v[164:167], a[120:123], a[180:183], v[164:167]
    ds_read_b128 a[144:147], v17 offset:49152
    buffer_store_dword v108, v109, s[52:55], s40 offen sc1
    v_mfma_f32_16x16x32_bf16 v[168:171], a[104:107], a[168:171], v[168:171]
    s_xor_b32 s32, s38, s39
    s_add_u32 m0, s33, 32768
    ds_read_b128 a[148:151], v17 offset:53248
    v_mfma_f32_16x16x32_bf16 v[168:171], a[120:123], a[184:187], v[168:171]
    ds_read_b128 a[152:155], v17 offset:57344
    buffer_load_dwordx4 v8, s[8:11], s32 offen offset:0 nt lds
    v_mfma_f32_16x16x32_bf16 v[172:175], a[104:107], a[172:175], v[172:175]
    ds_read_b128 a[156:159], v17 offset:61440
    v_mfma_f32_16x16x32_bf16 v[172:175], a[120:123], a[188:191], v[172:175]
    ds_read_b64_tr_b16 a[84:85], v29 offset:16384
    v_xor_b32 v102, 0x1000, v106
    v_mfma_f32_16x16x32_bf16 v[176:179], a[108:111], a[160:163], v[176:179]
    ds_read_b64_tr_b16 a[86:87], v29 offset:18432
    buffer_load_dwordx4 v9, s[8:11], s32 offen offset:1024 nt lds
    v_mfma_f32_16x16x32_bf16 v[176:179], a[124:127], a[176:179], v[176:179]
    ds_read_b64_tr_b16 a[88:89], v30 offset:16384
    v_xor_b32 v103, 0x1000, v107
    v_mfma_f32_16x16x32_bf16 v[180:183], a[108:111], a[164:167], v[180:183]
    ds_read_b64_tr_b16 a[90:91], v30 offset:18432
    v_mfma_f32_16x16x32_bf16 v[180:183], a[124:127], a[180:183], v[180:183]
    ds_read_b64_tr_b16 a[92:93], v31 offset:16384
    buffer_load_dwordx4 v10, s[8:11], s32 offen offset:2048 nt lds
    v_mfma_f32_16x16x32_bf16 v[184:187], a[108:111], a[168:171], v[184:187]
    ds_read_b64_tr_b16 a[94:95], v31 offset:18432
    v_mfma_f32_16x16x32_bf16 v[184:187], a[124:127], a[184:187], v[184:187]
    v_mfma_f32_16x16x32_bf16 v[188:191], a[108:111], a[172:175], v[188:191]
    buffer_load_dwordx4 v11, s[8:11], s32 offen offset:3072 nt lds
    v_mfma_f32_16x16x32_bf16 v[188:191], a[124:127], a[188:191], v[188:191]
    s_waitcnt lgkmcnt(2)
    s_add_u32 s38, s38, 16384
    v_mfma_f32_16x16x32_bf16 v[128:131], a[64:67], a[128:131], v[128:131]
    s_waitcnt vmcnt(9)
    ds_read_b64_tr_b16 a[96:97], v32 offset:0
    v_mfma_f32_16x16x32_bf16 v[128:131], a[80:83], a[144:147], v[128:131]
    ds_read_b64_tr_b16 a[98:99], v32 offset:2048
    v_mfma_f32_16x16x32_bf16 v[132:135], a[64:67], a[132:135], v[132:135]
    v_mfma_f32_16x16x32_bf16 v[132:135], a[80:83], a[148:151], v[132:135]
    ds_read_b128 a[160:163], v18 offset:49152
    v_mfma_f32_16x16x32_bf16 v[136:139], a[64:67], a[136:139], v[136:139]
    s_xor_b32 s32, s38, s39
    s_add_u32 m0, s33, 49152
    ds_read_b128 a[164:167], v18 offset:53248
    v_mfma_f32_16x16x32_bf16 v[136:139], a[80:83], a[152:155], v[136:139]
    ds_read_b128 a[168:171], v18 offset:57344
    buffer_load_dwordx4 v8, s[8:11], s32 offen offset:0 nt lds
    v_mfma_f32_16x16x32_bf16 v[140:143], a[64:67], a[140:143], v[140:143]
    ds_read_b128 a[172:175], v18 offset:61440
    v_mfma_f32_16x16x32_bf16 v[140:143], a[80:83], a[156:159], v[140:143]
    ds_read_b64_tr_b16 a[100:101], v33 offset:0
    v_mfma_f32_16x16x32_bf16 v[144:147], a[68:71], a[128:131], v[144:147]
    s_mov_b32 s42, 0x3e0293ee
    ds_read_b64_tr_b16 a[102:103], v33 offset:2048
    buffer_load_dwordx4 v9, s[8:11], s32 offen offset:1024 nt lds
    v_mfma_f32_16x16x32_bf16 v[144:147], a[84:87], a[144:147], v[144:147]
    ds_read_b64_tr_b16 a[104:105], v34 offset:0
    v_mfma_f32_16x16x32_bf16 v[148:151], a[68:71], a[132:135], v[148:151]
    ds_read_b64_tr_b16 a[106:107], v34 offset:2048
    v_mfma_f32_16x16x32_bf16 v[148:151], a[84:87], a[148:151], v[148:151]
    ds_read_b64_tr_b16 a[108:109], v35 offset:0
    buffer_load_dwordx4 v10, s[8:11], s32 offen offset:2048 nt lds
    v_mfma_f32_16x16x32_bf16 v[152:155], a[68:71], a[136:139], v[152:155]
    ds_read_b64_tr_b16 a[110:111], v35 offset:2048
    v_mfma_f32_16x16x32_bf16 v[152:155], a[84:87], a[152:155], v[152:155]
    v_mfma_f32_16x16x32_bf16 v[156:159], a[68:71], a[140:143], v[156:159]
    buffer_load_dwordx4 v11, s[8:11], s32 offen offset:3072 nt lds
    v_mfma_f32_16x16x32_bf16 v[156:159], a[84:87], a[156:159], v[156:159]
    s_add_u32 s38, s38, 16384
    v_mfma_f32_16x16x32_bf16 v[160:163], a[72:75], a[128:131], v[160:163]
    s_waitcnt vmcnt(9)
    ds_read_b64_tr_b16 a[112:113], v32 offset:16384
    v_mfma_f32_16x16x32_bf16 v[160:163], a[88:91], a[144:147], v[160:163]
    ds_read_b64_tr_b16 a[114:115], v32 offset:18432
    v_mfma_f32_16x16x32_bf16 v[164:167], a[72:75], a[132:135], v[164:167]
    v_mfma_f32_16x16x32_bf16 v[164:167], a[88:91], a[148:151], v[164:167]
    ds_read_b128 a[176:179], v19 offset:49152
    v_mfma_f32_16x16x32_bf16 v[168:171], a[72:75], a[136:139], v[168:171]
    ds_read_b128 a[180:183], v19 offset:53248
    v_mfma_f32_16x16x32_bf16 v[168:171], a[88:91], a[152:155], v[168:171]
    ds_read_b128 a[184:187], v19 offset:57344
    v_mfma_f32_16x16x32_bf16 v[172:175], a[72:75], a[140:143], v[172:175]
    ds_read_b128 a[188:191], v19 offset:61440
    v_mfma_f32_16x16x32_bf16 v[172:175], a[88:91], a[156:159], v[172:175]
    ds_read_b64_tr_b16 a[116:117], v33 offset:16384
    v_mfma_f32_16x16x32_bf16 v[176:179], a[76:79], a[128:131], v[176:179]
    s_waitcnt lgkmcnt(4)
    ds_read_b64_tr_b16 a[118:119], v33 offset:18432
    v_mfma_f32_16x16x32_bf16 v[176:179], a[92:95], a[144:147], v[176:179]
    ds_read_b64_tr_b16 a[120:121], v34 offset:16384
    v_mfma_f32_16x16x32_bf16 v[180:183], a[76:79], a[132:135], v[180:183]
    ds_read_b64_tr_b16 a[122:123], v34 offset:18432
    v_mfma_f32_16x16x32_bf16 v[180:183], a[92:95], a[148:151], v[180:183]
    ds_read_b64_tr_b16 a[124:125], v35 offset:16384
    v_mfma_f32_16x16x32_bf16 v[184:187], a[76:79], a[136:139], v[184:187]
    ds_read_b64_tr_b16 a[126:127], v35 offset:18432
    v_mfma_f32_16x16x32_bf16 v[184:187], a[92:95], a[152:155], v[184:187]
    v_mfma_f32_16x16x32_bf16 v[188:191], a[76:79], a[140:143], v[188:191]
    v_mfma_f32_16x16x32_bf16 v[188:191], a[92:95], a[156:159], v[188:191]
    v_mfma_f32_16x16x32_bf16 v[128:131], a[96:99], a[160:163], v[128:131]
    v_mfma_f32_16x16x32_bf16 v[128:131], a[112:115], a[176:179], v[128:131]
    s_barrier
    v_mfma_f32_16x16x32_bf16 v[144:147], a[100:103], a[160:163], v[144:147]
    s_waitcnt lgkmcnt(0)
    v_mfma_f32_16x16x32_bf16 v[144:147], a[116:119], a[176:179], v[144:147]
    v_mfma_f32_16x16x32_bf16 v[160:163], a[104:107], a[160:163], v[160:163]
    s_xor_b32 s32, s30, s39
    s_add_u32 m0, s33, 98304
    s_nop 0
    v_mul_f32 v128, s42, v128
    v_mul_f32 v129, s42, v129
    v_mul_f32 v130, s42, v130
    v_mfma_f32_16x16x32_bf16 v[160:163], a[120:123], a[176:179], v[160:163]
    buffer_load_dwordx4 v12, s[12:15], s32 offen offset:0 nt lds
    v_mul_f32 v131, s42, v131
    v_cvt_pk_bf16_f32 v128, v128, v129
    v_cvt_pk_bf16_f32 v129, v130, v131
    v_mfma_f32_16x16x32_bf16 v[176:179], a[108:111], a[160:163], v[176:179]
    ds_write_b64 v96, v[128:129] offset:0
    v_mul_f32 v144, s42, v144
    v_mul_f32 v145, s42, v145
    v_mul_f32 v146, s42, v146
    v_mfma_f32_16x16x32_bf16 v[176:179], a[124:127], a[176:179], v[176:179]
    v_mul_f32 v147, s42, v147
    v_cvt_pk_bf16_f32 v144, v144, v145
    v_cvt_pk_bf16_f32 v145, v146, v147
    v_mfma_f32_16x16x32_bf16 v[132:135], a[96:99], a[164:167], v[132:135]
    buffer_load_dwordx4 v13, s[12:15], s32 offen offset:1024 nt lds
    ds_write_b64 v97, v[144:145] offset:0
    v_mul_f32 v160, s42, v160
    v_mul_f32 v161, s42, v161
    v_mul_f32 v162, s42, v162
    v_mfma_f32_16x16x32_bf16 v[132:135], a[112:115], a[180:183], v[132:135]
    v_mul_f32 v163, s42, v163
    v_cvt_pk_bf16_f32 v160, v160, v161
    v_cvt_pk_bf16_f32 v161, v162, v163
    v_mfma_f32_16x16x32_bf16 v[148:151], a[100:103], a[164:167], v[148:151]
    ds_write_b64 v98, v[160:161] offset:0
    v_mul_f32 v176, s42, v176
    v_mul_f32 v177, s42, v177
    v_mul_f32 v178, s42, v178
    v_mfma_f32_16x16x32_bf16 v[148:151], a[116:119], a[180:183], v[148:151]
    buffer_load_dwordx4 v12, s[12:15], s32 offen offset:2048 nt lds
    v_mul_f32 v179, s42, v179
    v_cvt_pk_bf16_f32 v176, v176, v177
    v_cvt_pk_bf16_f32 v177, v178, v179
    v_mfma_f32_16x16x32_bf16 v[164:167], a[104:107], a[164:167], v[164:167]
    ds_write_b64 v99, v[176:177] offset:0
    v_mul_f32 v132, s42, v132
    v_mul_f32 v133, s42, v133
    v_mul_f32 v134, s42, v134
    v_mfma_f32_16x16x32_bf16 v[164:167], a[120:123], a[180:183], v[164:167]
    v_mul_f32 v135, s42, v135
    v_cvt_pk_bf16_f32 v132, v132, v133
    v_cvt_pk_bf16_f32 v133, v134, v135
    v_mfma_f32_16x16x32_bf16 v[180:183], a[108:111], a[164:167], v[180:183]
    buffer_load_dwordx4 v13, s[12:15], s32 offen offset:3072 nt lds
    ds_write_b64 v96, v[132:133] offset:4096
    v_mul_f32 v148, s42, v148
    v_mul_f32 v149, s42, v149
    v_mul_f32 v150, s42, v150
    v_mfma_f32_16x16x32_bf16 v[180:183], a[124:127], a[180:183], v[180:183]
    s_add_u32 s30, s30, 16384
    v_mul_f32 v151, s42, v151
    v_cvt_pk_bf16_f32 v148, v148, v149
    v_cvt_pk_bf16_f32 v149, v150, v151
    v_mfma_f32_16x16x32_bf16 v[136:139], a[96:99], a[168:171], v[136:139]
    ds_write_b64 v97, v[148:149] offset:4096
    v_mul_f32 v164, s42, v164
    v_mul_f32 v165, s42, v165
    v_mul_f32 v166, s42, v166
    v_mfma_f32_16x16x32_bf16 v[136:139], a[112:115], a[184:187], v[136:139]
    v_mul_f32 v167, s42, v167
    v_cvt_pk_bf16_f32 v164, v164, v165
    v_cvt_pk_bf16_f32 v165, v166, v167
    v_mfma_f32_16x16x32_bf16 v[152:155], a[100:103], a[168:171], v[152:155]
    ds_write_b64 v98, v[164:165] offset:4096
    v_mul_f32 v180, s42, v180
    v_mul_f32 v181, s42, v181
    v_mul_f32 v182, s42, v182
    v_mfma_f32_16x16x32_bf16 v[152:155], a[116:119], a[184:187], v[152:155]
    v_mul_f32 v183, s42, v183
    v_cvt_pk_bf16_f32 v180, v180, v181
    v_cvt_pk_bf16_f32 v181, v182, v183
    v_mfma_f32_16x16x32_bf16 v[168:171], a[104:107], a[168:171], v[168:171]
    s_xor_b32 s32, s30, s39
    s_add_u32 m0, s33, 114688
    ds_write_b64 v99, v[180:181] offset:4096
    v_mul_f32 v136, s42, v136
    v_mul_f32 v137, s42, v137
    v_mul_f32 v138, s42, v138
    v_mfma_f32_16x16x32_bf16 v[168:171], a[120:123], a[184:187], v[168:171]
    buffer_load_dwordx4 v12, s[12:15], s32 offen offset:0 nt lds
    v_mul_f32 v139, s42, v139
    v_cvt_pk_bf16_f32 v136, v136, v137
    v_cvt_pk_bf16_f32 v137, v138, v139
    v_mfma_f32_16x16x32_bf16 v[184:187], a[108:111], a[168:171], v[184:187]
    ds_write_b64 v96, v[136:137] offset:8192
    v_mul_f32 v152, s42, v152
    v_mul_f32 v153, s42, v153
    v_mul_f32 v154, s42, v154
    v_mfma_f32_16x16x32_bf16 v[184:187], a[124:127], a[184:187], v[184:187]
    v_mul_f32 v155, s42, v155
    v_cvt_pk_bf16_f32 v152, v152, v153
    v_cvt_pk_bf16_f32 v153, v154, v155
    v_mfma_f32_16x16x32_bf16 v[140:143], a[96:99], a[172:175], v[140:143]
    buffer_load_dwordx4 v13, s[12:15], s32 offen offset:1024 nt lds
    ds_write_b64 v97, v[152:153] offset:8192
    v_mul_f32 v168, s42, v168
    v_mul_f32 v169, s42, v169
    v_mul_f32 v170, s42, v170
    v_mfma_f32_16x16x32_bf16 v[140:143], a[112:115], a[188:191], v[140:143]
    v_mul_f32 v171, s42, v171
    v_cvt_pk_bf16_f32 v168, v168, v169
    v_cvt_pk_bf16_f32 v169, v170, v171
    v_mfma_f32_16x16x32_bf16 v[156:159], a[100:103], a[172:175], v[156:159]
    ds_write_b64 v98, v[168:169] offset:8192
    v_mul_f32 v184, s42, v184
    v_mul_f32 v185, s42, v185
    v_mul_f32 v186, s42, v186
    v_mfma_f32_16x16x32_bf16 v[156:159], a[116:119], a[188:191], v[156:159]
    buffer_load_dwordx4 v12, s[12:15], s32 offen offset:2048 nt lds
    v_mul_f32 v187, s42, v187
    v_cvt_pk_bf16_f32 v184, v184, v185
    v_cvt_pk_bf16_f32 v185, v186, v187
    v_mfma_f32_16x16x32_bf16 v[172:175], a[104:107], a[172:175], v[172:175]
    ds_write_b64 v99, v[184:185] offset:8192
    v_mul_f32 v140, s42, v140
    v_mul_f32 v141, s42, v141
    v_mul_f32 v142, s42, v142
    v_mfma_f32_16x16x32_bf16 v[172:175], a[120:123], a[188:191], v[172:175]
    v_mul_f32 v143, s42, v143
    v_cvt_pk_bf16_f32 v140, v140, v141
    v_cvt_pk_bf16_f32 v141, v142, v143
    v_mfma_f32_16x16x32_bf16 v[188:191], a[108:111], a[172:175], v[188:191]
    buffer_load_dwordx4 v13, s[12:15], s32 offen offset:3072 nt lds
    ds_write_b64 v96, v[140:141] offset:12288
    v_mul_f32 v156, s42, v156
    v_mul_f32 v157, s42, v157
    v_mul_f32 v158, s42, v158
    v_mfma_f32_16x16x32_bf16 v[188:191], a[124:127], a[188:191], v[188:191]
    s_add_u32 s30, s30, 16384
    v_mul_f32 v159, s42, v159
    v_cvt_pk_bf16_f32 v156, v156, v157
    v_cvt_pk_bf16_f32 v157, v158, v159
    ds_write_b64 v97, v[156:157] offset:12288
    v_mul_f32 v172, s42, v172
    v_mul_f32 v173, s42, v173
    v_mul_f32 v174, s42, v174
    v_mul_f32 v175, s42, v175
    v_cvt_pk_bf16_f32 v172, v172, v173
    v_cvt_pk_bf16_f32 v173, v174, v175
    ds_write_b64 v98, v[172:173] offset:12288
    v_mul_f32 v188, s42, v188
    v_mul_f32 v189, s42, v189
    v_mul_f32 v190, s42, v190
    v_mul_f32 v191, s42, v191
    v_cvt_pk_bf16_f32 v188, v188, v189
    v_cvt_pk_bf16_f32 v189, v190, v191
    ds_write_b64 v99, v[188:189] offset:12288
    s_waitcnt lgkmcnt(0)
    s_waitcnt vmcnt(8)
    s_barrier
    ds_read_b128 a[96:99], v16 offset:0
    ds_read_b128 a[0:3], v100 offset:0
    ds_read_b128 a[100:103], v17 offset:0
    ds_read_b128 a[4:7], v101 offset:0
    ds_read_b128 a[104:107], v18 offset:0
    ds_read_b128 a[8:11], v102 offset:0
    ds_read_b128 a[108:111], v19 offset:0
    ds_read_b128 a[12:15], v103 offset:0
    ds_read_b128 a[16:19], v104 offset:0
    ds_read_b128 a[20:23], v105 offset:0
    ds_read_b128 a[24:27], v106 offset:0
    ds_read_b128 a[28:31], v107 offset:0
    s_and_b32 s29, s28, 1
    s_lshl_b32 s63, s29, 13
    v_add_u32 v16, s63, v16
    v_add_u32 v17, s63, v17
    v_add_u32 v18, s63, v18
    v_add_u32 v19, s63, v19
    s_waitcnt lgkmcnt(10)
    v_mfma_f32_16x16x32_bf16 v[192:195], a[96:99], a[0:3], 0
    s_waitcnt lgkmcnt(8)
    ds_read_b128 a[32:35], v100 offset:8192
    ds_read_b128 a[36:39], v101 offset:8192
    v_mfma_f32_16x16x32_bf16 v[192:195], a[100:103], a[4:7], v[192:195]
    s_waitcnt lgkmcnt(8)
    s_xor_b32 s32, s38, s39
    s_add_u32 m0, s33, 65536
    ds_read_b128 a[40:43], v102 offset:8192
    ds_read_b128 a[44:47], v103 offset:8192
    v_mfma_f32_16x16x32_bf16 v[192:195], a[104:107], a[8:11], v[192:195]
    s_waitcnt lgkmcnt(8)
    ds_read_b128 a[48:51], v104 offset:8192
    ds_read_b128 a[52:55], v105 offset:8192
    buffer_load_dwordx4 v8, s[8:11], s32 offen offset:0 nt lds
    v_mfma_f32_16x16x32_bf16 v[192:195], a[108:111], a[12:15], v[192:195]
    s_waitcnt lgkmcnt(9)
    ds_read_b128 a[56:59], v106 offset:8192
    ds_read_b128 a[60:63], v107 offset:8192
    v_mfma_f32_16x16x32_bf16 v[196:199], a[96:99], a[16:19], 0
    s_waitcnt lgkmcnt(8)
    ds_read_b128 a[64:67], v16 offset:0
    ds_read_b128 a[68:71], v17 offset:0
    v_mfma_f32_16x16x32_bf16 v[196:199], a[100:103], a[20:23], v[196:199]
    ds_read_b128 a[72:75], v18 offset:0
    ds_read_b128 a[76:79], v19 offset:0
    buffer_load_dwordx4 v9, s[8:11], s32 offen offset:1024 nt lds
    v_mfma_f32_16x16x32_bf16 v[196:199], a[104:107], a[24:27], v[196:199]
    ds_read_b128 a[80:83], v16 offset:4096
    v_mfma_f32_16x16x32_bf16 v[196:199], a[108:111], a[28:31], v[196:199]
    s_waitcnt lgkmcnt(7)
    ds_read_b128 a[84:87], v17 offset:4096
    v_max3_f32 v192, v192, v193, v194
    v_max_f32 v192, v192, v195
    v_mfma_f32_16x16x32_bf16 v[200:203], a[96:99], a[32:35], 0
    ds_read_b128 a[88:91], v18 offset:4096
    buffer_load_dwordx4 v10, s[8:11], s32 offen offset:2048 nt lds
    v_mov_b32 v40, v192
    v_mfma_f32_16x16x32_bf16 v[200:203], a[100:103], a[36:39], v[200:203]
    ds_read_b128 a[92:95], v19 offset:4096
    v_mfma_f32_16x16x32_bf16 v[200:203], a[104:107], a[40:43], v[200:203]
    v_permlane32_swap_b32 v40, v192
    v_max_f32 v192, v192, v40
    v_mfma_f32_16x16x32_bf16 v[200:203], a[108:111], a[44:47], v[200:203]
    buffer_load_dwordx4 v11, s[8:11], s32 offen offset:3072 nt lds
    v_mov_b32 v40, v192
    v_mfma_f32_16x16x32_bf16 v[204:207], a[96:99], a[48:51], 0
    s_add_u32 s38, s38, 16384
    v_mfma_f32_16x16x32_bf16 v[204:207], a[100:103], a[52:55], v[204:207]
    s_waitcnt lgkmcnt(1)
    v_permlane16_swap_b32 v40, v192
    v_max_f32 v192, v192, v40
    v_mfma_f32_16x16x32_bf16 v[204:207], a[104:107], a[56:59], v[204:207]
    v_sub_f32 v40, 0, v192
    v_sub_f32 v41, 0, v192
    v_mfma_f32_16x16x32_bf16 v[204:207], a[108:111], a[60:63], v[204:207]
    v_sub_f32 v42, 0, v192
    v_sub_f32 v43, 0, v192
L_attn:
    s_nop 1
    v_mfma_f32_16x16x32_bf16 v[56:59], a[64:67], a[0:3], v[40:43]
    s_xor_b32 s32, s38, s39
    ds_read_b128 a[96:99], v16 offset:16384
    v_mfma_f32_16x16x32_bf16 v[56:59], a[68:71], a[4:7], v[56:59]
    s_add_u32 m0, s33, 81920
    ds_read_b128 a[100:103], v17 offset:16384
    v_mfma_f32_16x16x32_bf16 v[56:59], a[72:75], a[8:11], v[56:59]
    ds_read_b128 a[104:107], v18 offset:16384
    buffer_load_dwordx4 v8, s[8:11], s32 offen offset:0 nt lds
    v_mfma_f32_16x16x32_bf16 v[56:59], a[76:79], a[12:15], v[56:59]
    s_add_u32 s38, s38, 16384
    ds_read_b128 a[108:111], v19 offset:16384
    v_mfma_f32_16x16x32_bf16 v[60:63], a[80:83], a[0:3], v[40:43]
    ds_read_b128 a[112:115], v16 offset:20480
    v_mfma_f32_16x16x32_bf16 v[60:63], a[84:87], a[4:7], v[60:63]
    ds_read_b128 a[116:119], v17 offset:20480
    v_mfma_f32_16x16x32_bf16 v[60:63], a[88:91], a[8:11], v[60:63]
    s_waitcnt lgkmcnt(6)
    ds_read_b128 a[120:123], v18 offset:20480
    buffer_load_dwordx4 v9, s[8:11], s32 offen offset:1024 nt lds
    v_mfma_f32_16x16x32_bf16 v[60:63], a[92:95], a[12:15], v[60:63]
    ds_read_b128 a[124:127], v19 offset:20480
    v_max3_f32 v196, v196, v197, v198
    v_max_f32 v196, v196, v199
    v_mov_b32 v44, v196
    buffer_load_dwordx4 v10, s[8:11], s32 offen offset:2048 nt lds
    s_nop 0
    v_permlane32_swap_b32 v44, v196
    v_max_f32 v196, v196, v44
    v_exp_f32 v56, v56
    v_mov_b32 v44, v196
    v_exp_f32 v57, v57
    s_nop 0
    v_permlane16_swap_b32 v44, v196
    v_max_f32 v196, v196, v44
    v_sub_f32 v44, 0, v196
    v_sub_f32 v45, 0, v196
    s_waitcnt lgkmcnt(0)
    buffer_load_dwordx4 v11, s[8:11], s32 offen offset:3072 nt lds
    v_exp_f32 v58, v58
    v_sub_f32 v46, 0, v196
    v_sub_f32 v47, 0, v196
    v_mfma_f32_16x16x32_bf16 v[64:67], a[96:99], a[0:3], v[40:43]
    v_cvt_pk_bf16_f32 v88, v56, v57
    v_max3_f32 v200, v200, v201, v202
    v_max_f32 v200, v200, v203
    v_mfma_f32_16x16x32_bf16 v[64:67], a[100:103], a[4:7], v[64:67]
    v_exp_f32 v59, v59
    v_mov_b32 v48, v200
    v_mfma_f32_16x16x32_bf16 v[64:67], a[104:107], a[8:11], v[64:67]
    s_xor_b32 s32, s30, s39
    v_mfma_f32_16x16x32_bf16 v[64:67], a[108:111], a[12:15], v[64:67]
    s_add_u32 m0, s33, 131072
    v_exp_f32 v60, v60
    v_permlane32_swap_b32 v48, v200
    v_max_f32 v200, v200, v48
    v_mfma_f32_16x16x32_bf16 v[68:71], a[112:115], a[0:3], v[40:43]
    buffer_load_dwordx4 v12, s[12:15], s32 offen offset:0 nt lds
    v_cvt_pk_bf16_f32 v89, v58, v59
    v_mov_b32 v48, v200
    v_mfma_f32_16x16x32_bf16 v[68:71], a[116:119], a[4:7], v[68:71]
    s_add_u32 s30, s30, 16384
    v_exp_f32 v61, v61
    v_mfma_f32_16x16x32_bf16 v[68:71], a[120:123], a[8:11], v[68:71]
    v_permlane16_swap_b32 v48, v200
    v_max_f32 v200, v200, v48
    v_mfma_f32_16x16x32_bf16 v[68:71], a[124:127], a[12:15], v[68:71]
    v_exp_f32 v62, v62
    v_sub_f32 v48, 0, v200
    v_sub_f32 v49, 0, v200
    v_cvt_pk_bf16_f32 v90, v60, v61
    v_sub_f32 v50, 0, v200
    v_sub_f32 v51, 0, v200
    buffer_load_dwordx4 v13, s[12:15], s32 offen offset:1024 nt lds
    v_exp_f32 v63, v63
    s_nop 0
    v_cvt_pk_bf16_f32 v91, v62, v63
    s_waitcnt vmcnt(10)
    v_exp_f32 v64, v64
    s_barrier
    ds_read_b64_tr_b16 a[128:129], v20 offset:0
    ds_read_b64_tr_b16 a[130:131], v20 offset:4096
    buffer_load_dwordx4 v12, s[12:15], s32 offen offset:2048 nt lds
    v_exp_f32 v65, v65
    ds_read_b64_tr_b16 a[160:161], v20 offset:16384
    ds_read_b64_tr_b16 a[162:163], v20 offset:20480
    v_exp_f32 v66, v66
    v_mfma_f32_16x16x32_bf16 v[72:75], a[64:67], a[16:19], v[44:47]
    ds_read_b64_tr_b16 a[132:133], v21 offset:0
    v_cvt_pk_bf16_f32 v92, v64, v65
    v_max3_f32 v204, v204, v205, v206
    v_max_f32 v204, v204, v207
    v_mfma_f32_16x16x32_bf16 v[72:75], a[68:71], a[20:23], v[72:75]
    buffer_load_dwordx4 v13, s[12:15], s32 offen offset:3072 nt lds
    v_exp_f32 v67, v67
    v_mov_b32 v52, v204
    v_mfma_f32_16x16x32_bf16 v[72:75], a[72:75], a[24:27], v[72:75]
    ds_read_b64_tr_b16 a[134:135], v21 offset:4096
    v_mfma_f32_16x16x32_bf16 v[72:75], a[76:79], a[28:31], v[72:75]
    v_exp_f32 v68, v68
    v_permlane32_swap_b32 v52, v204
    v_max_f32 v204, v204, v52
    v_mfma_f32_16x16x32_bf16 v[76:79], a[80:83], a[16:19], v[44:47]
    s_xor_b32 s32, s30, s39
    ds_read_b64_tr_b16 a[164:165], v21 offset:16384
    v_cvt_pk_bf16_f32 v93, v66, v67
    v_mov_b32 v52, v204
    v_mfma_f32_16x16x32_bf16 v[76:79], a[84:87], a[20:23], v[76:79]
    s_add_u32 m0, s33, 147456
    v_exp_f32 v69, v69
    v_mfma_f32_16x16x32_bf16 v[76:79], a[88:91], a[24:27], v[76:79]
    buffer_load_dwordx4 v12, s[12:15], s32 offen offset:0 nt lds
    ds_read_b64_tr_b16 a[166:167], v21 offset:20480
    ds_read_b64_tr_b16 a[136:137], v22 offset:0
    v_permlane16_swap_b32 v52, v204
    v_max_f32 v204, v204, v52
    v_mfma_f32_16x16x32_bf16 v[76:79], a[92:95], a[28:31], v[76:79]
    s_add_u32 s30, s30, 16384
    v_exp_f32 v70, v70
    v_sub_f32 v52, 0, v204
    v_sub_f32 v53, 0, v204
    ds_read_b64_tr_b16 a[138:139], v22 offset:4096
    v_cvt_pk_bf16_f32 v94, v68, v69
    v_sub_f32 v54, 0, v204
    v_sub_f32 v55, 0, v204
    v_exp_f32 v71, v71
    ds_read_b64_tr_b16 a[168:169], v22 offset:16384
    buffer_load_dwordx4 v13, s[12:15], s32 offen offset:1024 nt lds
    ds_read_b64_tr_b16 a[170:171], v22 offset:20480
    v_cvt_pk_bf16_f32 v95, v70, v71
    v_exp_f32 v72, v72
    ds_read_b64_tr_b16 a[140:141], v23 offset:0
    ds_read_b64_tr_b16 a[142:143], v23 offset:4096
    v_exp_f32 v73, v73
    ds_read_b64_tr_b16 a[172:173], v23 offset:16384
    ds_read_b64_tr_b16 a[174:175], v23 offset:20480
    buffer_load_dwordx4 v12, s[12:15], s32 offen offset:2048 nt lds
    v_exp_f32 v74, v74
    v_mfma_f32_16x16x32_bf16 v[80:83], a[96:99], a[16:19], v[44:47]
    ds_read_b64_tr_b16 a[144:145], v24 offset:0
    v_cvt_pk_bf16_f32 v96, v72, v73
    v_mfma_f32_16x16x32_bf16 v[80:83], a[100:103], a[20:23], v[80:83]
    v_exp_f32 v75, v75
    v_mfma_f32_16x16x32_bf16 v[80:83], a[104:107], a[24:27], v[80:83]
    ds_read_b64_tr_b16 a[146:147], v24 offset:4096
    v_mfma_f32_16x16x32_bf16 v[80:83], a[108:111], a[28:31], v[80:83]
    v_exp_f32 v76, v76
    v_mfma_f32_16x16x32_bf16 v[84:87], a[112:115], a[16:19], v[44:47]
    buffer_load_dwordx4 v13, s[12:15], s32 offen offset:3072 nt lds
    ds_read_b64_tr_b16 a[176:177], v24 offset:16384
    v_cvt_pk_bf16_f32 v97, v74, v75
    v_mfma_f32_16x16x32_bf16 v[84:87], a[116:119], a[20:23], v[84:87]
    v_exp_f32 v77, v77
    v_mfma_f32_16x16x32_bf16 v[84:87], a[120:123], a[24:27], v[84:87]
    ds_read_b64_tr_b16 a[178:179], v24 offset:20480
    ds_read_b64_tr_b16 a[148:149], v25 offset:0
    v_mfma_f32_16x16x32_bf16 v[84:87], a[124:127], a[28:31], v[84:87]
    s_waitcnt lgkmcnt(5)
    v_exp_f32 v78, v78
    v_mfma_f32_16x16x32_bf16 v[128:131], a[128:131], v[88:91], 0
    ds_read_b64_tr_b16 a[150:151], v25 offset:4096
    v_cvt_pk_bf16_f32 v98, v76, v77
    v_mfma_f32_16x16x32_bf16 v[128:131], a[160:163], v[92:95], v[128:131]
    v_exp_f32 v79, v79
    v_mfma_f32_16x16x32_bf16 v[144:147], a[132:135], v[88:91], 0
    ds_read_b64_tr_b16 a[180:181], v25 offset:16384
    v_mfma_f32_16x16x32_bf16 v[144:147], a[164:167], v[92:95], v[144:147]
    ds_read_b64_tr_b16 a[182:183], v25 offset:20480
    v_cvt_pk_bf16_f32 v99, v78, v79
    v_mfma_f32_16x16x32_bf16 v[160:163], a[136:139], v[88:91], 0
    v_exp_f32 v80, v80
    v_mfma_f32_16x16x32_bf16 v[160:163], a[168:171], v[92:95], v[160:163]
    ds_read_b64_tr_b16 a[152:153], v26 offset:0
    ds_read_b64_tr_b16 a[154:155], v26 offset:4096
    v_mfma_f32_16x16x32_bf16 v[176:179], a[140:143], v[88:91], 0
    v_exp_f32 v81, v81
    v_mfma_f32_16x16x32_bf16 v[176:179], a[172:175], v[92:95], v[176:179]
    ds_read_b64_tr_b16 a[184:185], v26 offset:16384
    ds_read_b64_tr_b16 a[186:187], v26 offset:20480
    v_mfma_f32_16x16x32_bf16 v[104:107], v[120:123], v[88:91], 0
    v_exp_f32 v82, v82
    v_mfma_f32_16x16x32_bf16 v[56:59], a[64:67], a[32:35], v[48:51]
    s_xor_b32 s32, s38, s39
    ds_read_b64_tr_b16 a[156:157], v27 offset:0
    v_cvt_pk_bf16_f32 v100, v80, v81
    v_mfma_f32_16x16x32_bf16 v[56:59], a[68:71], a[36:39], v[56:59]
    s_add_u32 m0, s33, 32768
    v_exp_f32 v83, v83
    v_mfma_f32_16x16x32_bf16 v[56:59], a[72:75], a[40:43], v[56:59]
    s_lshr_b32 s16, s35, 2
    buffer_load_dwordx4 v8, s[8:11], s32 offen offset:0 nt lds
    ds_read_b64_tr_b16 a[158:159], v27 offset:4096
    v_mfma_f32_16x16x32_bf16 v[56:59], a[76:79], a[44:47], v[56:59]
    s_add_u32 s38, s38, 16384
    v_exp_f32 v84, v84
    v_mfma_f32_16x16x32_bf16 v[60:63], a[80:83], a[32:35], v[48:51]
    s_add_u32 s16, s16, 0
    ds_read_b64_tr_b16 a[188:189], v27 offset:16384
    v_cvt_pk_bf16_f32 v101, v82, v83
    v_mfma_f32_16x16x32_bf16 v[60:63], a[84:87], a[36:39], v[60:63]
    s_add_u32 s46, s16, s34
    v_exp_f32 v85, v85
    v_mfma_f32_16x16x32_bf16 v[60:63], a[88:91], a[40:43], v[60:63]
    s_and_b32 s46, s46, 3
    ds_read_b64_tr_b16 a[190:191], v27 offset:20480
    v_bfe_u32 v6, v2, 4, 1
    v_mfma_f32_16x16x32_bf16 v[60:63], a[92:95], a[44:47], v[60:63]
    s_waitcnt lgkmcnt(4)
    s_lshl_b32 s46, s46, 8
    v_exp_f32 v86, v86
    v_mfma_f32_16x16x32_bf16 v[192:195], a[144:147], v[88:91], 0
    s_and_b32 s16, s16, 3
    v_cvt_pk_bf16_f32 v102, v84, v85
    v_and_b32 v7, 3, v2
    v_mfma_f32_16x16x32_bf16 v[192:195], a[176:179], v[92:95], v[192:195]
    s_lshl_b32 s16, s16, 18
    v_exp_f32 v87, v87
    v_mfma_f32_16x16x32_bf16 v[208:211], a[148:151], v[88:91], 0
    s_lshr_b32 s17, s35, 2
    buffer_load_dwordx4 v9, s[8:11], s32 offen offset:1024 nt lds
    v_mfma_f32_16x16x32_bf16 v[208:211], a[180:183], v[92:95], v[208:211]
    s_add_u32 s17, s17, 1
    v_cvt_pk_bf16_f32 v103, v86, v87
    v_lshlrev_b32 v5, 1, v6
    v_mfma_f32_16x16x32_bf16 v[224:227], a[152:155], v[88:91], 0
    s_add_u32 s47, s17, s34
    v_exp_f32 v56, v56
    v_mfma_f32_16x16x32_bf16 v[224:227], a[184:187], v[92:95], v[224:227]
    s_waitcnt lgkmcnt(1)
    s_and_b32 s47, s47, 3
    v_xor_b32 v5, v5, v7
    v_mfma_f32_16x16x32_bf16 v[240:243], a[156:159], v[88:91], 0
    s_waitcnt lgkmcnt(0)
    s_lshl_b32 s47, s47, 8
    v_exp_f32 v57, v57
    v_mfma_f32_16x16x32_bf16 v[240:243], a[188:191], v[92:95], v[240:243]
    s_and_b32 s17, s17, 3
    v_lshlrev_b32 v5, 4, v5
    v_mfma_f32_16x16x32_bf16 v[104:107], v[120:123], v[92:95], v[104:107]
    s_lshl_b32 s17, s17, 18
    v_exp_f32 v58, v58
    v_mfma_f32_16x16x32_bf16 v[64:67], a[96:99], a[32:35], v[48:51]
    s_lshr_b32 s18, s35, 2
    v_cvt_pk_bf16_f32 v88, v56, v57
    v_lshl_add_u32 v5, v1, 6, v5
    v_mfma_f32_16x16x32_bf16 v[64:67], a[100:103], a[36:39], v[64:67]
    s_add_u32 s18, s18, 2
    v_exp_f32 v59, v59
    v_mfma_f32_16x16x32_bf16 v[64:67], a[104:107], a[40:43], v[64:67]
    s_add_u32 s48, s18, s34
    buffer_load_dwordx4 v10, s[8:11], s32 offen offset:2048 nt lds
    v_mfma_f32_16x16x32_bf16 v[64:67], a[108:111], a[44:47], v[64:67]
    s_and_b32 s48, s48, 3
    v_exp_f32 v60, v60
    v_mfma_f32_16x16x32_bf16 v[68:71], a[112:115], a[32:35], v[48:51]
    s_lshl_b32 s48, s48, 8
    v_cvt_pk_bf16_f32 v89, v58, v59
    v_lshrrev_b32 v34, 2, v2
    v_mfma_f32_16x16x32_bf16 v[68:71], a[116:119], a[36:39], v[68:71]
    s_and_b32 s18, s18, 3
    v_exp_f32 v61, v61
    v_mfma_f32_16x16x32_bf16 v[68:71], a[120:123], a[40:43], v[68:71]
    s_lshl_b32 s18, s18, 18
    v_lshl_add_u32 v36, v34, 10, v5
    v_mfma_f32_16x16x32_bf16 v[68:71], a[124:127], a[44:47], v[68:71]
    s_lshr_b32 s19, s35, 2
    v_exp_f32 v62, v62
    v_mfma_f32_16x16x32_bf16 v[132:135], a[128:131], v[96:99], 0
    s_add_u32 s19, s19, 3
    v_cvt_pk_bf16_f32 v90, v60, v61
    v_add_u32 v37, 15360, v36
    v_mfma_f32_16x16x32_bf16 v[132:135], a[160:163], v[100:103], v[132:135]
    s_add_u32 s49, s19, s34
    v_exp_f32 v63, v63
    v_mfma_f32_16x16x32_bf16 v[148:151], a[132:135], v[96:99], 0
    s_and_b32 s49, s49, 3
    buffer_load_dwordx4 v11, s[8:11], s32 offen offset:3072 nt lds
    v_mfma_f32_16x16x32_bf16 v[148:151], a[164:167], v[100:103], v[148:151]
    s_lshl_b32 s49, s49, 8
    v_cvt_pk_bf16_f32 v91, v62, v63
    v_add_u32 v38, 30720, v36
    v_mfma_f32_16x16x32_bf16 v[164:167], a[136:139], v[96:99], 0
    s_waitcnt vmcnt(12)
    v_exp_f32 v64, v64
    v_mfma_f32_16x16x32_bf16 v[164:167], a[168:171], v[100:103], v[164:167]
    s_barrier
    v_add_u32 v39, 46080, v36
    v_mfma_f32_16x16x32_bf16 v[180:183], a[140:143], v[96:99], 0
    s_and_b32 s19, s19, 3
    v_exp_f32 v65, v65
    v_mfma_f32_16x16x32_bf16 v[180:183], a[172:175], v[100:103], v[180:183]
    s_lshl_b32 s19, s19, 18
    v_lshlrev_b32 v7, 3, v7
    v_mfma_f32_16x16x32_bf16 v[108:111], v[120:123], v[96:99], 0
    s_mov_b64 s[4:5], s[36:37]
    v_exp_f32 v66, v66
    v_mfma_f32_16x16x32_bf16 v[72:75], a[64:67], a[48:51], v[52:55]
    s_xor_b32 s32, s38, s39
    v_cvt_pk_bf16_f32 v92, v64, v65
    v_lshl_add_u32 v7, v6, 5, v7
    v_mfma_f32_16x16x32_bf16 v[72:75], a[68:71], a[52:55], v[72:75]
    s_add_u32 m0, s33, 49152
    v_exp_f32 v67, v67
    v_mfma_f32_16x16x32_bf16 v[72:75], a[72:75], a[56:59], v[72:75]
    s_mov_b32 s6, 0x100000
    buffer_load_dwordx4 v8, s[8:11], s32 offen offset:0 nt lds
    v_mfma_f32_16x16x32_bf16 v[72:75], a[76:79], a[60:63], v[72:75]
    s_add_u32 s38, s38, 16384
    v_exp_f32 v68, v68
    v_mfma_f32_16x16x32_bf16 v[76:79], a[80:83], a[48:51], v[52:55]
    s_lshl_b32 s45, s34, 2
    ds_read_b128 a[64:67], v16 offset:32768
    v_cvt_pk_bf16_f32 v93, v66, v67
    v_mfma_f32_16x16x32_bf16 v[76:79], a[84:87], a[52:55], v[76:79]
    s_and_b32 s64, s35, 3
    v_exp_f32 v69, v69
    v_mfma_f32_16x16x32_bf16 v[76:79], a[88:91], a[56:59], v[76:79]
    s_add_u32 s45, s45, s64
    ds_read_b128 a[68:71], v17 offset:32768
    v_lshl_add_u32 v7, v34, 6, v7
    v_mfma_f32_16x16x32_bf16 v[76:79], a[92:95], a[60:63], v[76:79]
    s_lshl_b32 s45, s45, 15
    v_exp_f32 v70, v70
    v_mfma_f32_16x16x32_bf16 v[196:199], a[144:147], v[96:99], 0
    s_lshr_b32 s65, s100, 3
    ds_read_b128 a[72:75], v18 offset:32768
    v_cvt_pk_bf16_f32 v94, v68, v69
    v_mfma_f32_16x16x32_bf16 v[196:199], a[176:179], v[100:103], v[196:199]
    s_lshl_b32 s65, s65, 10
    v_exp_f32 v71, v71
    v_mfma_f32_16x16x32_bf16 v[212:215], a[148:151], v[96:99], 0
    s_add_u32 s45, s45, s65
    buffer_load_dwordx4 v9, s[8:11], s32 offen offset:1024 nt lds
    v_mfma_f32_16x16x32_bf16 v[212:215], a[180:183], v[100:103], v[212:215]
    s_add_u32 s45, s45, s46
    ds_read_b128 a[76:79], v19 offset:32768
    v_cvt_pk_bf16_f32 v95, v70, v71
    v_mfma_f32_16x16x32_bf16 v[228:231], a[152:155], v[96:99], 0
    s_movk_i32 s54, 0x100
    v_exp_f32 v72, v72
    v_mfma_f32_16x16x32_bf16 v[228:231], a[184:187], v[100:103], v[228:231]
    ds_read_b128 a[80:83], v16 offset:36864
    v_lshl_add_u32 v28, v1, 12, v7
    v_mfma_f32_16x16x32_bf16 v[244:247], a[156:159], v[96:99], 0
    v_exp_f32 v73, v73
    v_mfma_f32_16x16x32_bf16 v[244:247], a[188:191], v[100:103], v[244:247]
    ds_read_b128 a[84:87], v17 offset:36864
    v_xor_b32 v29, 32, v28
    v_mfma_f32_16x16x32_bf16 v[108:111], v[120:123], v[100:103], v[108:111]
    v_exp_f32 v74, v74
    v_mfma_f32_16x16x32_bf16 v[80:83], a[96:99], a[48:51], v[52:55]
    ds_read_b128 a[88:91], v18 offset:36864
    v_cvt_pk_bf16_f32 v96, v72, v73
    v_mfma_f32_16x16x32_bf16 v[80:83], a[100:103], a[52:55], v[80:83]
    v_exp_f32 v75, v75
    v_mfma_f32_16x16x32_bf16 v[80:83], a[104:107], a[56:59], v[80:83]
    buffer_load_dwordx4 v10, s[8:11], s32 offen offset:2048 nt lds
    v_mfma_f32_16x16x32_bf16 v[80:83], a[108:111], a[60:63], v[80:83]
    v_exp_f32 v76, v76
    v_mfma_f32_16x16x32_bf16 v[84:87], a[112:115], a[48:51], v[52:55]
    ds_read_b128 a[92:95], v19 offset:36864
    v_cvt_pk_bf16_f32 v97, v74, v75
    v_mfma_f32_16x16x32_bf16 v[84:87], a[116:119], a[52:55], v[84:87]
    v_exp_f32 v77, v77
    v_mfma_f32_16x16x32_bf16 v[84:87], a[120:123], a[56:59], v[84:87]
    ds_read_b128 a[96:99], v16 offset:49152
    v_add_u32 v30, 0x10000, v28
    v_mfma_f32_16x16x32_bf16 v[84:87], a[124:127], a[60:63], v[84:87]
    v_exp_f32 v78, v78
    v_mfma_f32_16x16x32_bf16 v[136:139], a[128:131], v[88:91], 0
    ds_read_b128 a[100:103], v17 offset:49152
    v_cvt_pk_bf16_f32 v98, v76, v77
    v_mfma_f32_16x16x32_bf16 v[136:139], a[160:163], v[92:95], v[136:139]
    v_exp_f32 v79, v79
    v_mfma_f32_16x16x32_bf16 v[152:155], a[132:135], v[88:91], 0
    buffer_load_dwordx4 v11, s[8:11], s32 offen offset:3072 nt lds
    v_mfma_f32_16x16x32_bf16 v[152:155], a[164:167], v[92:95], v[152:155]
    ds_read_b128 a[104:107], v18 offset:49152
    v_cvt_pk_bf16_f32 v99, v78, v79
    v_mfma_f32_16x16x32_bf16 v[168:171], a[136:139], v[88:91], 0
    v_exp_f32 v80, v80
    v_mfma_f32_16x16x32_bf16 v[168:171], a[168:171], v[92:95], v[168:171]
    ds_read_b128 a[108:111], v19 offset:49152
    v_add_u32 v31, 0x10000, v29
    v_mfma_f32_16x16x32_bf16 v[184:187], a[140:143], v[88:91], 0
    v_exp_f32 v81, v81
    v_mfma_f32_16x16x32_bf16 v[184:187], a[172:175], v[92:95], v[184:187]
    v_add_u32 v32, 0x20000, v28
    v_mfma_f32_16x16x32_bf16 v[112:115], v[120:123], v[88:91], 0
    s_waitcnt lgkmcnt(2)
    v_exp_f32 v82, v82
    v_mfma_f32_16x16x32_bf16 v[56:59], a[64:67], a[0:3], v[40:43]
    s_xor_b32 s32, s30, s39
    ds_read_b128 a[112:115], v16 offset:53248
    v_cvt_pk_bf16_f32 v100, v80, v81
    v_mfma_f32_16x16x32_bf16 v[56:59], a[68:71], a[4:7], v[56:59]
    s_add_u32 m0, s33, 98304
    v_exp_f32 v83, v83
    v_mfma_f32_16x16x32_bf16 v[56:59], a[72:75], a[8:11], v[56:59]
    buffer_load_dwordx4 v12, s[12:15], s32 offen offset:0 nt lds
    v_mfma_f32_16x16x32_bf16 v[56:59], a[76:79], a[12:15], v[56:59]
    s_add_u32 s30, s30, 16384
    v_exp_f32 v84, v84
    v_mfma_f32_16x16x32_bf16 v[60:63], a[80:83], a[0:3], v[40:43]
    ds_read_b128 a[116:119], v17 offset:53248
    v_cvt_pk_bf16_f32 v101, v82, v83
    v_mfma_f32_16x16x32_bf16 v[60:63], a[84:87], a[4:7], v[60:63]
    v_exp_f32 v85, v85
    v_mfma_f32_16x16x32_bf16 v[60:63], a[88:91], a[8:11], v[60:63]
    ds_read_b128 a[120:123], v18 offset:53248
    v_add_u32 v33, 0x20000, v29
    v_mfma_f32_16x16x32_bf16 v[60:63], a[92:95], a[12:15], v[60:63]
    v_exp_f32 v86, v86
    v_mfma_f32_16x16x32_bf16 v[200:203], a[144:147], v[88:91], 0
    ds_read_b128 a[124:127], v19 offset:53248
    v_cvt_pk_bf16_f32 v102, v84, v85
    v_mfma_f32_16x16x32_bf16 v[200:203], a[176:179], v[92:95], v[200:203]
    v_exp_f32 v87, v87
    v_mfma_f32_16x16x32_bf16 v[216:219], a[148:151], v[88:91], 0
    buffer_load_dwordx4 v13, s[12:15], s32 offen offset:1024 nt lds
    v_mfma_f32_16x16x32_bf16 v[216:219], a[180:183], v[92:95], v[216:219]
    v_cvt_pk_bf16_f32 v103, v86, v87
    v_mfma_f32_16x16x32_bf16 v[232:235], a[152:155], v[88:91], 0
    v_exp_f32 v56, v56
    v_mfma_f32_16x16x32_bf16 v[232:235], a[184:187], v[92:95], v[232:235]
    v_mfma_f32_16x16x32_bf16 v[248:251], a[156:159], v[88:91], 0
    v_exp_f32 v57, v57
    v_mfma_f32_16x16x32_bf16 v[248:251], a[188:191], v[92:95], v[248:251]
    v_mfma_f32_16x16x32_bf16 v[112:115], v[120:123], v[92:95], v[112:115]
    v_exp_f32 v58, v58
    v_mfma_f32_16x16x32_bf16 v[64:67], a[96:99], a[0:3], v[40:43]
    v_cvt_pk_bf16_f32 v88, v56, v57
    v_mfma_f32_16x16x32_bf16 v[64:67], a[100:103], a[4:7], v[64:67]
    s_waitcnt lgkmcnt(0)
    v_exp_f32 v59, v59
    v_mfma_f32_16x16x32_bf16 v[64:67], a[104:107], a[8:11], v[64:67]
    buffer_load_dwordx4 v12, s[12:15], s32 offen offset:2048 nt lds
    v_mfma_f32_16x16x32_bf16 v[64:67], a[108:111], a[12:15], v[64:67]
    v_exp_f32 v60, v60
    v_mfma_f32_16x16x32_bf16 v[68:71], a[112:115], a[0:3], v[40:43]
    v_cvt_pk_bf16_f32 v89, v58, v59
    v_mfma_f32_16x16x32_bf16 v[68:71], a[116:119], a[4:7], v[68:71]
    v_exp_f32 v61, v61
    v_mfma_f32_16x16x32_bf16 v[68:71], a[120:123], a[8:11], v[68:71]
    v_mfma_f32_16x16x32_bf16 v[68:71], a[124:127], a[12:15], v[68:71]
    v_exp_f32 v62, v62
    v_mfma_f32_16x16x32_bf16 v[140:143], a[128:131], v[96:99], 0
    v_cvt_pk_bf16_f32 v90, v60, v61
    v_mfma_f32_16x16x32_bf16 v[140:143], a[160:163], v[100:103], v[140:143]
    v_exp_f32 v63, v63
    v_mfma_f32_16x16x32_bf16 v[156:159], a[132:135], v[96:99], 0
    buffer_load_dwordx4 v13, s[12:15], s32 offen offset:3072 nt lds
    v_mfma_f32_16x16x32_bf16 v[156:159], a[164:167], v[100:103], v[156:159]
    v_cvt_pk_bf16_f32 v91, v62, v63
    v_mfma_f32_16x16x32_bf16 v[172:175], a[136:139], v[96:99], 0
    s_waitcnt vmcnt(12)
    v_exp_f32 v64, v64
    v_mfma_f32_16x16x32_bf16 v[172:175], a[168:171], v[100:103], v[172:175]
    s_barrier
    ds_read_b64_tr_b16 a[128:129], v20 offset:32768
    ds_read_b64_tr_b16 a[130:131], v20 offset:36864
    v_mfma_f32_16x16x32_bf16 v[188:191], a[140:143], v[96:99], 0
    v_exp_f32 v65, v65
    v_mfma_f32_16x16x32_bf16 v[188:191], a[172:175], v[100:103], v[188:191]
    ds_read_b64_tr_b16 a[160:161], v20 offset:49152
    ds_read_b64_tr_b16 a[162:163], v20 offset:53248
    v_mfma_f32_16x16x32_bf16 v[116:119], v[120:123], v[96:99], 0
    v_exp_f32 v66, v66
    v_mfma_f32_16x16x32_bf16 v[72:75], a[64:67], a[16:19], v[44:47]
    s_xor_b32 s32, s30, s39
    ds_read_b64_tr_b16 a[132:133], v21 offset:32768
    v_cvt_pk_bf16_f32 v92, v64, v65
    v_mfma_f32_16x16x32_bf16 v[72:75], a[68:71], a[20:23], v[72:75]
    s_add_u32 m0, s33, 114688
    v_exp_f32 v67, v67
    v_mfma_f32_16x16x32_bf16 v[72:75], a[72:75], a[24:27], v[72:75]
    buffer_load_dwordx4 v12, s[12:15], s32 offen offset:0 nt lds
    ds_read_b64_tr_b16 a[134:135], v21 offset:36864
    v_mfma_f32_16x16x32_bf16 v[72:75], a[76:79], a[28:31], v[72:75]
    s_add_u32 s30, s30, 16384
    v_exp_f32 v68, v68
    v_mfma_f32_16x16x32_bf16 v[76:79], a[80:83], a[16:19], v[44:47]
    ds_read_b64_tr_b16 a[164:165], v21 offset:49152
    v_cvt_pk_bf16_f32 v93, v66, v67
    v_mfma_f32_16x16x32_bf16 v[76:79], a[84:87], a[20:23], v[76:79]
    v_exp_f32 v69, v69
    v_mfma_f32_16x16x32_bf16 v[76:79], a[88:91], a[24:27], v[76:79]
    ds_read_b64_tr_b16 a[166:167], v21 offset:53248
    ds_read_b64_tr_b16 a[136:137], v22 offset:32768
    v_mfma_f32_16x16x32_bf16 v[76:79], a[92:95], a[28:31], v[76:79]
    v_exp_f32 v70, v70
    v_mfma_f32_16x16x32_bf16 v[204:207], a[144:147], v[96:99], 0
    ds_read_b64_tr_b16 a[138:139], v22 offset:36864
    v_cvt_pk_bf16_f32 v94, v68, v69
    v_mfma_f32_16x16x32_bf16 v[204:207], a[176:179], v[100:103], v[204:207]
    v_exp_f32 v71, v71
    v_mfma_f32_16x16x32_bf16 v[220:223], a[148:151], v[96:99], 0
    buffer_load_dwordx4 v13, s[12:15], s32 offen offset:1024 nt lds
    ds_read_b64_tr_b16 a[168:169], v22 offset:49152
    v_mfma_f32_16x16x32_bf16 v[220:223], a[180:183], v[100:103], v[220:223]
    ds_read_b64_tr_b16 a[170:171], v22 offset:53248
    v_cvt_pk_bf16_f32 v95, v70, v71
    v_mfma_f32_16x16x32_bf16 v[236:239], a[152:155], v[96:99], 0
    v_exp_f32 v72, v72
    v_mfma_f32_16x16x32_bf16 v[236:239], a[184:187], v[100:103], v[236:239]
    ds_read_b64_tr_b16 a[140:141], v23 offset:32768
    ds_read_b64_tr_b16 a[142:143], v23 offset:36864
    v_mfma_f32_16x16x32_bf16 v[252:255], a[156:159], v[96:99], 0
    v_exp_f32 v73, v73
    v_mfma_f32_16x16x32_bf16 v[252:255], a[188:191], v[100:103], v[252:255]
    ds_read_b64_tr_b16 a[172:173], v23 offset:49152
    ds_read_b64_tr_b16 a[174:175], v23 offset:53248
    v_mfma_f32_16x16x32_bf16 v[116:119], v[120:123], v[100:103], v[116:119]
    v_exp_f32 v74, v74
    v_mfma_f32_16x16x32_bf16 v[80:83], a[96:99], a[16:19], v[44:47]
    ds_read_b64_tr_b16 a[144:145], v24 offset:32768
    v_cvt_pk_bf16_f32 v96, v72, v73
    v_mfma_f32_16x16x32_bf16 v[80:83], a[100:103], a[20:23], v[80:83]
    v_exp_f32 v75, v75
    v_mfma_f32_16x16x32_bf16 v[80:83], a[104:107], a[24:27], v[80:83]
    buffer_load_dwordx4 v12, s[12:15], s32 offen offset:2048 nt lds
    ds_read_b64_tr_b16 a[146:147], v24 offset:36864
    v_mfma_f32_16x16x32_bf16 v[80:83], a[108:111], a[28:31], v[80:83]
    v_exp_f32 v76, v76
    v_mfma_f32_16x16x32_bf16 v[84:87], a[112:115], a[16:19], v[44:47]
    ds_read_b64_tr_b16 a[176:177], v24 offset:49152
    v_cvt_pk_bf16_f32 v97, v74, v75
    v_mfma_f32_16x16x32_bf16 v[84:87], a[116:119], a[20:23], v[84:87]
    v_exp_f32 v77, v77
    v_mfma_f32_16x16x32_bf16 v[84:87], a[120:123], a[24:27], v[84:87]
    ds_read_b64_tr_b16 a[178:179], v24 offset:53248
    ds_read_b64_tr_b16 a[148:149], v25 offset:32768
    v_mfma_f32_16x16x32_bf16 v[84:87], a[124:127], a[28:31], v[84:87]
    s_waitcnt lgkmcnt(5)
    v_exp_f32 v78, v78
    v_mfma_f32_16x16x32_bf16 v[128:131], a[128:131], v[88:91], v[128:131]
    ds_read_b64_tr_b16 a[150:151], v25 offset:36864
    v_cvt_pk_bf16_f32 v98, v76, v77
    v_mfma_f32_16x16x32_bf16 v[128:131], a[160:163], v[92:95], v[128:131]
    v_exp_f32 v79, v79
    v_mfma_f32_16x16x32_bf16 v[144:147], a[132:135], v[88:91], v[144:147]
    buffer_load_dwordx4 v13, s[12:15], s32 offen offset:3072 nt lds
    ds_read_b64_tr_b16 a[180:181], v25 offset:49152
    v_mfma_f32_16x16x32_bf16 v[144:147], a[164:167], v[92:95], v[144:147]
    ds_read_b64_tr_b16 a[182:183], v25 offset:53248
    v_cvt_pk_bf16_f32 v99, v78, v79
    v_mfma_f32_16x16x32_bf16 v[160:163], a[136:139], v[88:91], v[160:163]
    v_exp_f32 v80, v80
    v_mfma_f32_16x16x32_bf16 v[160:163], a[168:171], v[92:95], v[160:163]
    ds_read_b64_tr_b16 a[152:153], v26 offset:32768
    ds_read_b64_tr_b16 a[154:155], v26 offset:36864
    v_mfma_f32_16x16x32_bf16 v[176:179], a[140:143], v[88:91], v[176:179]
    v_exp_f32 v81, v81
    v_mfma_f32_16x16x32_bf16 v[176:179], a[172:175], v[92:95], v[176:179]
    ds_read_b64_tr_b16 a[184:185], v26 offset:49152
    ds_read_b64_tr_b16 a[186:187], v26 offset:53248
    v_mfma_f32_16x16x32_bf16 v[104:107], v[120:123], v[88:91], v[104:107]
    v_exp_f32 v82, v82
    v_mfma_f32_16x16x32_bf16 v[56:59], a[64:67], a[32:35], v[48:51]
    s_xor_b32 s32, s38, s39
    ds_read_b64_tr_b16 a[156:157], v27 offset:32768
    v_cvt_pk_bf16_f32 v100, v80, v81
    v_mfma_f32_16x16x32_bf16 v[56:59], a[68:71], a[36:39], v[56:59]
    s_add_u32 m0, s33, 65536
    v_exp_f32 v83, v83
    v_mfma_f32_16x16x32_bf16 v[56:59], a[72:75], a[40:43], v[56:59]
    buffer_load_dwordx4 v8, s[8:11], s32 offen offset:0 nt lds
    ds_read_b64_tr_b16 a[158:159], v27 offset:36864
    v_mfma_f32_16x16x32_bf16 v[56:59], a[76:79], a[44:47], v[56:59]
    s_add_u32 s38, s38, 16384
    v_exp_f32 v84, v84
    v_mfma_f32_16x16x32_bf16 v[60:63], a[80:83], a[32:35], v[48:51]
    ds_read_b64_tr_b16 a[188:189], v27 offset:49152
    v_cvt_pk_bf16_f32 v101, v82, v83
    v_mfma_f32_16x16x32_bf16 v[60:63], a[84:87], a[36:39], v[60:63]
    v_exp_f32 v85, v85
    v_mfma_f32_16x16x32_bf16 v[60:63], a[88:91], a[40:43], v[60:63]
    ds_read_b64_tr_b16 a[190:191], v27 offset:53248
    v_add_u32 v126, 98304, v14
    v_mfma_f32_16x16x32_bf16 v[60:63], a[92:95], a[44:47], v[60:63]
    s_waitcnt lgkmcnt(4)
    v_exp_f32 v86, v86
    v_mfma_f32_16x16x32_bf16 v[192:195], a[144:147], v[88:91], v[192:195]
    v_cvt_pk_bf16_f32 v102, v84, v85
    v_lshl_add_u32 v124, v1, 12, v126
    v_mfma_f32_16x16x32_bf16 v[192:195], a[176:179], v[92:95], v[192:195]
    v_exp_f32 v87, v87
    v_mfma_f32_16x16x32_bf16 v[208:211], a[148:151], v[88:91], v[208:211]
    buffer_load_dwordx4 v9, s[8:11], s32 offen offset:1024 nt lds
    v_mfma_f32_16x16x32_bf16 v[208:211], a[180:183], v[92:95], v[208:211]
    v_cvt_pk_bf16_f32 v103, v86, v87
    v_xor_b32 v125, 0x1000, v124
    v_mfma_f32_16x16x32_bf16 v[224:227], a[152:155], v[88:91], v[224:227]
    v_exp_f32 v56, v56
    v_mfma_f32_16x16x32_bf16 v[224:227], a[184:187], v[92:95], v[224:227]
    s_waitcnt lgkmcnt(1)
    v_lshlrev_b32 v5, 2, v0
    v_mfma_f32_16x16x32_bf16 v[240:243], a[156:159], v[88:91], v[240:243]
    s_waitcnt lgkmcnt(0)
    v_exp_f32 v57, v57
    v_mfma_f32_16x16x32_bf16 v[240:243], a[188:191], v[92:95], v[240:243]
    v_add_u32 v5, 81920, v5
    v_mfma_f32_16x16x32_bf16 v[104:107], v[120:123], v[92:95], v[104:107]
    v_exp_f32 v58, v58
    v_mfma_f32_16x16x32_bf16 v[64:67], a[96:99], a[32:35], v[48:51]
    v_cvt_pk_bf16_f32 v88, v56, v57
    v_xor_b32 v6, 256, v5
    v_mfma_f32_16x16x32_bf16 v[64:67], a[100:103], a[36:39], v[64:67]
    v_exp_f32 v59, v59
    v_mfma_f32_16x16x32_bf16 v[64:67], a[104:107], a[40:43], v[64:67]
    buffer_load_dwordx4 v10, s[8:11], s32 offen offset:2048 nt lds
    v_mfma_f32_16x16x32_bf16 v[64:67], a[108:111], a[44:47], v[64:67]
    v_exp_f32 v60, v60
    v_mfma_f32_16x16x32_bf16 v[68:71], a[112:115], a[32:35], v[48:51]
    v_cvt_pk_bf16_f32 v89, v58, v59
    v_lshl_add_u32 v7, v1, 2, v14
    v_mfma_f32_16x16x32_bf16 v[68:71], a[116:119], a[36:39], v[68:71]
    v_exp_f32 v61, v61
    v_mfma_f32_16x16x32_bf16 v[68:71], a[120:123], a[40:43], v[68:71]
    v_add_u32 v7, 83968, v7
    v_mfma_f32_16x16x32_bf16 v[68:71], a[124:127], a[44:47], v[68:71]
    v_exp_f32 v62, v62
    v_mfma_f32_16x16x32_bf16 v[132:135], a[128:131], v[96:99], v[132:135]
    v_cvt_pk_bf16_f32 v90, v60, v61
    v_mfma_f32_16x16x32_bf16 v[132:135], a[160:163], v[100:103], v[132:135]
    v_exp_f32 v63, v63
    v_mfma_f32_16x16x32_bf16 v[148:151], a[132:135], v[96:99], v[148:151]
    buffer_load_dwordx4 v11, s[8:11], s32 offen offset:3072 nt lds
    v_mfma_f32_16x16x32_bf16 v[148:151], a[164:167], v[100:103], v[148:151]
    v_cvt_pk_bf16_f32 v91, v62, v63
    v_mfma_f32_16x16x32_bf16 v[164:167], a[136:139], v[96:99], v[164:167]
    s_waitcnt vmcnt(12)
    v_exp_f32 v64, v64
    v_mfma_f32_16x16x32_bf16 v[164:167], a[168:171], v[100:103], v[164:167]
    s_barrier
    v_mfma_f32_16x16x32_bf16 v[180:183], a[140:143], v[96:99], v[180:183]
    v_exp_f32 v65, v65
    v_mfma_f32_16x16x32_bf16 v[180:183], a[172:175], v[100:103], v[180:183]
    v_mfma_f32_16x16x32_bf16 v[108:111], v[120:123], v[96:99], v[108:111]
    v_exp_f32 v66, v66
    v_mfma_f32_16x16x32_bf16 v[72:75], a[64:67], a[48:51], v[52:55]
    s_xor_b32 s32, s38, s39
    v_cvt_pk_bf16_f32 v92, v64, v65
    v_mfma_f32_16x16x32_bf16 v[72:75], a[68:71], a[52:55], v[72:75]
    s_add_u32 m0, s33, 81920
    v_exp_f32 v67, v67
    v_mfma_f32_16x16x32_bf16 v[72:75], a[72:75], a[56:59], v[72:75]
    buffer_load_dwordx4 v8, s[8:11], s32 offen offset:0 nt lds
    v_mfma_f32_16x16x32_bf16 v[72:75], a[76:79], a[60:63], v[72:75]
    s_add_u32 s38, s38, 16384
    v_exp_f32 v68, v68
    v_mfma_f32_16x16x32_bf16 v[76:79], a[80:83], a[48:51], v[52:55]
    ds_read_b128 a[64:67], v16 offset:0
    v_cvt_pk_bf16_f32 v93, v66, v67
    v_mfma_f32_16x16x32_bf16 v[76:79], a[84:87], a[52:55], v[76:79]
    v_exp_f32 v69, v69
    v_mfma_f32_16x16x32_bf16 v[76:79], a[88:91], a[56:59], v[76:79]
    ds_read_b128 a[68:71], v17 offset:0
    v_mfma_f32_16x16x32_bf16 v[76:79], a[92:95], a[60:63], v[76:79]
    v_exp_f32 v70, v70
    v_mfma_f32_16x16x32_bf16 v[196:199], a[144:147], v[96:99], v[196:199]
    ds_read_b128 a[72:75], v18 offset:0
    v_cvt_pk_bf16_f32 v94, v68, v69
    v_mfma_f32_16x16x32_bf16 v[196:199], a[176:179], v[100:103], v[196:199]
    v_exp_f32 v71, v71
    v_mfma_f32_16x16x32_bf16 v[212:215], a[148:151], v[96:99], v[212:215]
    buffer_load_dwordx4 v9, s[8:11], s32 offen offset:1024 nt lds
    v_mfma_f32_16x16x32_bf16 v[212:215], a[180:183], v[100:103], v[212:215]
    ds_read_b128 a[76:79], v19 offset:0
    v_cvt_pk_bf16_f32 v95, v70, v71
    v_mfma_f32_16x16x32_bf16 v[228:231], a[152:155], v[96:99], v[228:231]
    v_exp_f32 v72, v72
    v_mfma_f32_16x16x32_bf16 v[228:231], a[184:187], v[100:103], v[228:231]
    ds_read_b128 a[80:83], v16 offset:4096
    v_mfma_f32_16x16x32_bf16 v[244:247], a[156:159], v[96:99], v[244:247]
    v_exp_f32 v73, v73
    v_mfma_f32_16x16x32_bf16 v[244:247], a[188:191], v[100:103], v[244:247]
    ds_read_b128 a[84:87], v17 offset:4096
    v_mfma_f32_16x16x32_bf16 v[108:111], v[120:123], v[100:103], v[108:111]
    v_exp_f32 v74, v74
    v_mfma_f32_16x16x32_bf16 v[80:83], a[96:99], a[48:51], v[52:55]
    ds_read_b128 a[88:91], v18 offset:4096
    v_cvt_pk_bf16_f32 v96, v72, v73
    v_mfma_f32_16x16x32_bf16 v[80:83], a[100:103], a[52:55], v[80:83]
    v_exp_f32 v75, v75
    v_mfma_f32_16x16x32_bf16 v[80:83], a[104:107], a[56:59], v[80:83]
    buffer_load_dwordx4 v10, s[8:11], s32 offen offset:2048 nt lds
    v_mfma_f32_16x16x32_bf16 v[80:83], a[108:111], a[60:63], v[80:83]
    v_exp_f32 v76, v76
    v_mfma_f32_16x16x32_bf16 v[84:87], a[112:115], a[48:51], v[52:55]
    ds_read_b128 a[92:95], v19 offset:4096
    v_cvt_pk_bf16_f32 v97, v74, v75
    v_mfma_f32_16x16x32_bf16 v[84:87], a[116:119], a[52:55], v[84:87]
    v_exp_f32 v77, v77
    v_mfma_f32_16x16x32_bf16 v[84:87], a[120:123], a[56:59], v[84:87]
    ds_read_b128 a[96:99], v16 offset:16384
    v_mfma_f32_16x16x32_bf16 v[84:87], a[124:127], a[60:63], v[84:87]
    v_exp_f32 v78, v78
    v_mfma_f32_16x16x32_bf16 v[136:139], a[128:131], v[88:91], v[136:139]
    ds_read_b128 a[100:103], v17 offset:16384
    v_cvt_pk_bf16_f32 v98, v76, v77
    v_mfma_f32_16x16x32_bf16 v[136:139], a[160:163], v[92:95], v[136:139]
    s_mov_b32 s31, 0
    v_exp_f32 v79, v79
    v_mfma_f32_16x16x32_bf16 v[152:155], a[132:135], v[88:91], v[152:155]
    buffer_load_dwordx4 v11, s[8:11], s32 offen offset:3072 nt lds
    v_mfma_f32_16x16x32_bf16 v[152:155], a[164:167], v[92:95], v[152:155]
    ds_read_b128 a[104:107], v18 offset:16384
    v_cvt_pk_bf16_f32 v99, v78, v79
    v_mfma_f32_16x16x32_bf16 v[168:171], a[136:139], v[88:91], v[168:171]
    v_exp_f32 v80, v80
    v_mfma_f32_16x16x32_bf16 v[168:171], a[168:171], v[92:95], v[168:171]
    ds_read_b128 a[108:111], v19 offset:16384
    v_mfma_f32_16x16x32_bf16 v[184:187], a[140:143], v[88:91], v[184:187]
    v_exp_f32 v81, v81
    v_mfma_f32_16x16x32_bf16 v[184:187], a[172:175], v[92:95], v[184:187]
L_loop:
    v_mfma_f32_16x16x32_bf16 v[112:115], v[120:123], v[88:91], v[112:115]
    s_waitcnt lgkmcnt(2)
    v_exp_f32 v82, v82
    v_mfma_f32_16x16x32_bf16 v[56:59], a[64:67], a[0:3], v[40:43]
    s_xor_b32 s32, s30, s39
    ds_read_b128 a[112:115], v16 offset:20480
    v_cvt_pk_bf16_f32 v100, v80, v81
    v_mfma_f32_16x16x32_bf16 v[56:59], a[68:71], a[4:7], v[56:59]
    s_add_u32 m0, s33, 131072
    v_exp_f32 v83, v83
    v_mfma_f32_16x16x32_bf16 v[56:59], a[72:75], a[8:11], v[56:59]
    buffer_load_dwordx4 v12, s[12:15], s32 offen offset:0 nt lds
    v_mfma_f32_16x16x32_bf16 v[56:59], a[76:79], a[12:15], v[56:59]
    s_add_u32 s30, s30, 16384
    v_exp_f32 v84, v84
    v_mfma_f32_16x16x32_bf16 v[60:63], a[80:83], a[0:3], v[40:43]
    ds_read_b128 a[116:119], v17 offset:20480
    v_cvt_pk_bf16_f32 v101, v82, v83
    v_mfma_f32_16x16x32_bf16 v[60:63], a[84:87], a[4:7], v[60:63]
    v_exp_f32 v85, v85
    v_mfma_f32_16x16x32_bf16 v[60:63], a[88:91], a[8:11], v[60:63]
    ds_read_b128 a[120:123], v18 offset:20480
    v_mfma_f32_16x16x32_bf16 v[60:63], a[92:95], a[12:15], v[60:63]
    v_exp_f32 v86, v86
    v_mfma_f32_16x16x32_bf16 v[200:203], a[144:147], v[88:91], v[200:203]
    ds_read_b128 a[124:127], v19 offset:20480
    v_cvt_pk_bf16_f32 v102, v84, v85
    v_mfma_f32_16x16x32_bf16 v[200:203], a[176:179], v[92:95], v[200:203]
    v_exp_f32 v87, v87
    v_mfma_f32_16x16x32_bf16 v[216:219], a[148:151], v[88:91], v[216:219]
    buffer_load_dwordx4 v13, s[12:15], s32 offen offset:1024 nt lds
    v_mfma_f32_16x16x32_bf16 v[216:219], a[180:183], v[92:95], v[216:219]
    v_cvt_pk_bf16_f32 v103, v86, v87
    v_mfma_f32_16x16x32_bf16 v[232:235], a[152:155], v[88:91], v[232:235]
    v_exp_f32 v56, v56
    v_mfma_f32_16x16x32_bf16 v[232:235], a[184:187], v[92:95], v[232:235]
    v_mfma_f32_16x16x32_bf16 v[248:251], a[156:159], v[88:91], v[248:251]
    v_exp_f32 v57, v57
    v_mfma_f32_16x16x32_bf16 v[248:251], a[188:191], v[92:95], v[248:251]
    v_mfma_f32_16x16x32_bf16 v[112:115], v[120:123], v[92:95], v[112:115]
    v_exp_f32 v58, v58
    v_mfma_f32_16x16x32_bf16 v[64:67], a[96:99], a[0:3], v[40:43]
    v_cvt_pk_bf16_f32 v88, v56, v57
    v_mfma_f32_16x16x32_bf16 v[64:67], a[100:103], a[4:7], v[64:67]
    s_waitcnt lgkmcnt(0)
    v_exp_f32 v59, v59
    v_mfma_f32_16x16x32_bf16 v[64:67], a[104:107], a[8:11], v[64:67]
    buffer_load_dwordx4 v12, s[12:15], s32 offen offset:2048 nt lds
    v_mfma_f32_16x16x32_bf16 v[64:67], a[108:111], a[12:15], v[64:67]
    v_exp_f32 v60, v60
    v_mfma_f32_16x16x32_bf16 v[68:71], a[112:115], a[0:3], v[40:43]
    v_cvt_pk_bf16_f32 v89, v58, v59
    v_mfma_f32_16x16x32_bf16 v[68:71], a[116:119], a[4:7], v[68:71]
    v_exp_f32 v61, v61
    v_mfma_f32_16x16x32_bf16 v[68:71], a[120:123], a[8:11], v[68:71]
    v_mfma_f32_16x16x32_bf16 v[68:71], a[124:127], a[12:15], v[68:71]
    v_exp_f32 v62, v62
    v_mfma_f32_16x16x32_bf16 v[140:143], a[128:131], v[96:99], v[140:143]
    v_cvt_pk_bf16_f32 v90, v60, v61
    v_mfma_f32_16x16x32_bf16 v[140:143], a[160:163], v[100:103], v[140:143]
    v_exp_f32 v63, v63
    v_mfma_f32_16x16x32_bf16 v[156:159], a[132:135], v[96:99], v[156:159]
    buffer_load_dwordx4 v13, s[12:15], s32 offen offset:3072 nt lds
    v_mfma_f32_16x16x32_bf16 v[156:159], a[164:167], v[100:103], v[156:159]
    v_cvt_pk_bf16_f32 v91, v62, v63
    v_mfma_f32_16x16x32_bf16 v[172:175], a[136:139], v[96:99], v[172:175]
    s_waitcnt vmcnt(12)
    v_exp_f32 v64, v64
    v_mfma_f32_16x16x32_bf16 v[172:175], a[168:171], v[100:103], v[172:175]
    s_barrier
    ds_read_b64_tr_b16 a[128:129], v20 offset:0
    ds_read_b64_tr_b16 a[130:131], v20 offset:4096
    v_mfma_f32_16x16x32_bf16 v[188:191], a[140:143], v[96:99], v[188:191]
    v_exp_f32 v65, v65
    v_mfma_f32_16x16x32_bf16 v[188:191], a[172:175], v[100:103], v[188:191]
    ds_read_b64_tr_b16 a[160:161], v20 offset:16384
    ds_read_b64_tr_b16 a[162:163], v20 offset:20480
    v_mfma_f32_16x16x32_bf16 v[116:119], v[120:123], v[96:99], v[116:119]
    v_exp_f32 v66, v66
    v_mfma_f32_16x16x32_bf16 v[72:75], a[64:67], a[16:19], v[44:47]
    s_xor_b32 s32, s30, s39
    ds_read_b64_tr_b16 a[132:133], v21 offset:0
    v_cvt_pk_bf16_f32 v92, v64, v65
    v_mfma_f32_16x16x32_bf16 v[72:75], a[68:71], a[20:23], v[72:75]
    s_add_u32 m0, s33, 147456
    v_exp_f32 v67, v67
    v_mfma_f32_16x16x32_bf16 v[72:75], a[72:75], a[24:27], v[72:75]
    buffer_load_dwordx4 v12, s[12:15], s32 offen offset:0 nt lds
    ds_read_b64_tr_b16 a[134:135], v21 offset:4096
    v_mfma_f32_16x16x32_bf16 v[72:75], a[76:79], a[28:31], v[72:75]
    s_add_u32 s30, s30, 16384
    v_exp_f32 v68, v68
    v_mfma_f32_16x16x32_bf16 v[76:79], a[80:83], a[16:19], v[44:47]
    ds_read_b64_tr_b16 a[164:165], v21 offset:16384
    v_cvt_pk_bf16_f32 v93, v66, v67
    v_mfma_f32_16x16x32_bf16 v[76:79], a[84:87], a[20:23], v[76:79]
    v_exp_f32 v69, v69
    v_mfma_f32_16x16x32_bf16 v[76:79], a[88:91], a[24:27], v[76:79]
    ds_read_b64_tr_b16 a[166:167], v21 offset:20480
    ds_read_b64_tr_b16 a[136:137], v22 offset:0
    v_mfma_f32_16x16x32_bf16 v[76:79], a[92:95], a[28:31], v[76:79]
    v_exp_f32 v70, v70
    v_mfma_f32_16x16x32_bf16 v[204:207], a[144:147], v[96:99], v[204:207]
    ds_read_b64_tr_b16 a[138:139], v22 offset:4096
    v_cvt_pk_bf16_f32 v94, v68, v69
    v_mfma_f32_16x16x32_bf16 v[204:207], a[176:179], v[100:103], v[204:207]
    v_exp_f32 v71, v71
    v_mfma_f32_16x16x32_bf16 v[220:223], a[148:151], v[96:99], v[220:223]
    buffer_load_dwordx4 v13, s[12:15], s32 offen offset:1024 nt lds
    ds_read_b64_tr_b16 a[168:169], v22 offset:16384
    v_mfma_f32_16x16x32_bf16 v[220:223], a[180:183], v[100:103], v[220:223]
    ds_read_b64_tr_b16 a[170:171], v22 offset:20480
    v_cvt_pk_bf16_f32 v95, v70, v71
    v_mfma_f32_16x16x32_bf16 v[236:239], a[152:155], v[96:99], v[236:239]
    v_exp_f32 v72, v72
    v_mfma_f32_16x16x32_bf16 v[236:239], a[184:187], v[100:103], v[236:239]
    ds_read_b64_tr_b16 a[140:141], v23 offset:0
    ds_read_b64_tr_b16 a[142:143], v23 offset:4096
    v_mfma_f32_16x16x32_bf16 v[252:255], a[156:159], v[96:99], v[252:255]
    v_exp_f32 v73, v73
    v_mfma_f32_16x16x32_bf16 v[252:255], a[188:191], v[100:103], v[252:255]
    ds_read_b64_tr_b16 a[172:173], v23 offset:16384
    ds_read_b64_tr_b16 a[174:175], v23 offset:20480
    v_mfma_f32_16x16x32_bf16 v[116:119], v[120:123], v[100:103], v[116:119]
    v_exp_f32 v74, v74
    v_mfma_f32_16x16x32_bf16 v[80:83], a[96:99], a[16:19], v[44:47]
    ds_read_b64_tr_b16 a[144:145], v24 offset:0
    v_cvt_pk_bf16_f32 v96, v72, v73
    v_mfma_f32_16x16x32_bf16 v[80:83], a[100:103], a[20:23], v[80:83]
    v_exp_f32 v75, v75
    v_mfma_f32_16x16x32_bf16 v[80:83], a[104:107], a[24:27], v[80:83]
    buffer_load_dwordx4 v12, s[12:15], s32 offen offset:2048 nt lds
    ds_read_b64_tr_b16 a[146:147], v24 offset:4096
    v_mfma_f32_16x16x32_bf16 v[80:83], a[108:111], a[28:31], v[80:83]
    v_exp_f32 v76, v76
    v_mfma_f32_16x16x32_bf16 v[84:87], a[112:115], a[16:19], v[44:47]
    ds_read_b64_tr_b16 a[176:177], v24 offset:16384
    v_cvt_pk_bf16_f32 v97, v74, v75
    v_mfma_f32_16x16x32_bf16 v[84:87], a[116:119], a[20:23], v[84:87]
    v_exp_f32 v77, v77
    v_mfma_f32_16x16x32_bf16 v[84:87], a[120:123], a[24:27], v[84:87]
    ds_read_b64_tr_b16 a[178:179], v24 offset:20480
    ds_read_b64_tr_b16 a[148:149], v25 offset:0
    v_mfma_f32_16x16x32_bf16 v[84:87], a[124:127], a[28:31], v[84:87]
    s_waitcnt lgkmcnt(5)
    v_exp_f32 v78, v78
    v_mfma_f32_16x16x32_bf16 v[128:131], a[128:131], v[88:91], v[128:131]
    ds_read_b64_tr_b16 a[150:151], v25 offset:4096
    v_cvt_pk_bf16_f32 v98, v76, v77
    v_mfma_f32_16x16x32_bf16 v[128:131], a[160:163], v[92:95], v[128:131]
    v_exp_f32 v79, v79
    v_mfma_f32_16x16x32_bf16 v[144:147], a[132:135], v[88:91], v[144:147]
    buffer_load_dwordx4 v13, s[12:15], s32 offen offset:3072 nt lds
    ds_read_b64_tr_b16 a[180:181], v25 offset:16384
    v_mfma_f32_16x16x32_bf16 v[144:147], a[164:167], v[92:95], v[144:147]
    ds_read_b64_tr_b16 a[182:183], v25 offset:20480
    v_cvt_pk_bf16_f32 v99, v78, v79
    v_mfma_f32_16x16x32_bf16 v[160:163], a[136:139], v[88:91], v[160:163]
    v_exp_f32 v80, v80
    v_mfma_f32_16x16x32_bf16 v[160:163], a[168:171], v[92:95], v[160:163]
    ds_read_b64_tr_b16 a[152:153], v26 offset:0
    ds_read_b64_tr_b16 a[154:155], v26 offset:4096
    v_mfma_f32_16x16x32_bf16 v[176:179], a[140:143], v[88:91], v[176:179]
    v_exp_f32 v81, v81
    v_mfma_f32_16x16x32_bf16 v[176:179], a[172:175], v[92:95], v[176:179]
    ds_read_b64_tr_b16 a[184:185], v26 offset:16384
    ds_read_b64_tr_b16 a[186:187], v26 offset:20480
    v_mfma_f32_16x16x32_bf16 v[104:107], v[120:123], v[88:91], v[104:107]
    v_exp_f32 v82, v82
    v_mfma_f32_16x16x32_bf16 v[56:59], a[64:67], a[32:35], v[48:51]
    s_xor_b32 s32, s38, s39
    ds_read_b64_tr_b16 a[156:157], v27 offset:0
    v_cvt_pk_bf16_f32 v100, v80, v81
    v_mfma_f32_16x16x32_bf16 v[56:59], a[68:71], a[36:39], v[56:59]
    s_add_u32 m0, s33, 32768
    v_exp_f32 v83, v83
    v_mfma_f32_16x16x32_bf16 v[56:59], a[72:75], a[40:43], v[56:59]
    buffer_load_dwordx4 v8, s[8:11], s32 offen offset:0 nt lds
    ds_read_b64_tr_b16 a[158:159], v27 offset:4096
    v_mfma_f32_16x16x32_bf16 v[56:59], a[76:79], a[44:47], v[56:59]
    s_add_u32 s38, s38, 16384
    v_exp_f32 v84, v84
    v_mfma_f32_16x16x32_bf16 v[60:63], a[80:83], a[32:35], v[48:51]
    ds_read_b64_tr_b16 a[188:189], v27 offset:16384
    v_cvt_pk_bf16_f32 v101, v82, v83
    v_mfma_f32_16x16x32_bf16 v[60:63], a[84:87], a[36:39], v[60:63]
    v_exp_f32 v85, v85
    v_mfma_f32_16x16x32_bf16 v[60:63], a[88:91], a[40:43], v[60:63]
    ds_read_b64_tr_b16 a[190:191], v27 offset:20480
    v_mfma_f32_16x16x32_bf16 v[60:63], a[92:95], a[44:47], v[60:63]
    s_waitcnt lgkmcnt(4)
    v_exp_f32 v86, v86
    v_mfma_f32_16x16x32_bf16 v[192:195], a[144:147], v[88:91], v[192:195]
    v_cvt_pk_bf16_f32 v102, v84, v85
    v_mfma_f32_16x16x32_bf16 v[192:195], a[176:179], v[92:95], v[192:195]
    v_exp_f32 v87, v87
    v_mfma_f32_16x16x32_bf16 v[208:211], a[148:151], v[88:91], v[208:211]
    buffer_load_dwordx4 v9, s[8:11], s32 offen offset:1024 nt lds
    v_mfma_f32_16x16x32_bf16 v[208:211], a[180:183], v[92:95], v[208:211]
    v_cvt_pk_bf16_f32 v103, v86, v87
    v_mfma_f32_16x16x32_bf16 v[224:227], a[152:155], v[88:91], v[224:227]
    v_exp_f32 v56, v56
    v_mfma_f32_16x16x32_bf16 v[224:227], a[184:187], v[92:95], v[224:227]
    s_waitcnt lgkmcnt(1)
    v_mfma_f32_16x16x32_bf16 v[240:243], a[156:159], v[88:91], v[240:243]
    s_waitcnt lgkmcnt(0)
    v_exp_f32 v57, v57
    v_mfma_f32_16x16x32_bf16 v[240:243], a[188:191], v[92:95], v[240:243]
    v_mfma_f32_16x16x32_bf16 v[104:107], v[120:123], v[92:95], v[104:107]
    v_exp_f32 v58, v58
    v_mfma_f32_16x16x32_bf16 v[64:67], a[96:99], a[32:35], v[48:51]
    v_cvt_pk_bf16_f32 v88, v56, v57
    v_mfma_f32_16x16x32_bf16 v[64:67], a[100:103], a[36:39], v[64:67]
    v_exp_f32 v59, v59
    v_mfma_f32_16x16x32_bf16 v[64:67], a[104:107], a[40:43], v[64:67]
    buffer_load_dwordx4 v10, s[8:11], s32 offen offset:2048 nt lds
    v_mfma_f32_16x16x32_bf16 v[64:67], a[108:111], a[44:47], v[64:67]
    v_exp_f32 v60, v60
    v_mfma_f32_16x16x32_bf16 v[68:71], a[112:115], a[32:35], v[48:51]
    v_cvt_pk_bf16_f32 v89, v58, v59
    v_mfma_f32_16x16x32_bf16 v[68:71], a[116:119], a[36:39], v[68:71]
    v_exp_f32 v61, v61
    v_mfma_f32_16x16x32_bf16 v[68:71], a[120:123], a[40:43], v[68:71]
    v_mfma_f32_16x16x32_bf16 v[68:71], a[124:127], a[44:47], v[68:71]
    v_exp_f32 v62, v62
    v_mfma_f32_16x16x32_bf16 v[132:135], a[128:131], v[96:99], v[132:135]
    v_cvt_pk_bf16_f32 v90, v60, v61
    v_mfma_f32_16x16x32_bf16 v[132:135], a[160:163], v[100:103], v[132:135]
    v_exp_f32 v63, v63
    v_mfma_f32_16x16x32_bf16 v[148:151], a[132:135], v[96:99], v[148:151]
    buffer_load_dwordx4 v11, s[8:11], s32 offen offset:3072 nt lds
    v_mfma_f32_16x16x32_bf16 v[148:151], a[164:167], v[100:103], v[148:151]
    v_cvt_pk_bf16_f32 v91, v62, v63
    v_mfma_f32_16x16x32_bf16 v[164:167], a[136:139], v[96:99], v[164:167]
    s_waitcnt vmcnt(12)
    v_exp_f32 v64, v64
    v_mfma_f32_16x16x32_bf16 v[164:167], a[168:171], v[100:103], v[164:167]
    s_barrier
    v_mfma_f32_16x16x32_bf16 v[180:183], a[140:143], v[96:99], v[180:183]
    v_exp_f32 v65, v65
    v_mfma_f32_16x16x32_bf16 v[180:183], a[172:175], v[100:103], v[180:183]
    v_mfma_f32_16x16x32_bf16 v[108:111], v[120:123], v[96:99], v[108:111]
    v_exp_f32 v66, v66
    v_mfma_f32_16x16x32_bf16 v[72:75], a[64:67], a[48:51], v[52:55]
    s_xor_b32 s32, s38, s39
    v_cvt_pk_bf16_f32 v92, v64, v65
    v_mfma_f32_16x16x32_bf16 v[72:75], a[68:71], a[52:55], v[72:75]
    s_add_u32 m0, s33, 49152
    v_exp_f32 v67, v67
    v_mfma_f32_16x16x32_bf16 v[72:75], a[72:75], a[56:59], v[72:75]
    buffer_load_dwordx4 v8, s[8:11], s32 offen offset:0 nt lds
    v_mfma_f32_16x16x32_bf16 v[72:75], a[76:79], a[60:63], v[72:75]
    s_add_u32 s38, s38, 16384
    v_exp_f32 v68, v68
    v_mfma_f32_16x16x32_bf16 v[76:79], a[80:83], a[48:51], v[52:55]
    ds_read_b128 a[64:67], v16 offset:32768
    v_cvt_pk_bf16_f32 v93, v66, v67
    v_mfma_f32_16x16x32_bf16 v[76:79], a[84:87], a[52:55], v[76:79]
    v_exp_f32 v69, v69
    v_mfma_f32_16x16x32_bf16 v[76:79], a[88:91], a[56:59], v[76:79]
    ds_read_b128 a[68:71], v17 offset:32768
    v_mfma_f32_16x16x32_bf16 v[76:79], a[92:95], a[60:63], v[76:79]
    v_exp_f32 v70, v70
    v_mfma_f32_16x16x32_bf16 v[196:199], a[144:147], v[96:99], v[196:199]
    ds_read_b128 a[72:75], v18 offset:32768
    v_cvt_pk_bf16_f32 v94, v68, v69
    v_mfma_f32_16x16x32_bf16 v[196:199], a[176:179], v[100:103], v[196:199]
    v_exp_f32 v71, v71
    v_mfma_f32_16x16x32_bf16 v[212:215], a[148:151], v[96:99], v[212:215]
    buffer_load_dwordx4 v9, s[8:11], s32 offen offset:1024 nt lds
    v_mfma_f32_16x16x32_bf16 v[212:215], a[180:183], v[100:103], v[212:215]
    ds_read_b128 a[76:79], v19 offset:32768
    v_cvt_pk_bf16_f32 v95, v70, v71
    v_mfma_f32_16x16x32_bf16 v[228:231], a[152:155], v[96:99], v[228:231]
    v_exp_f32 v72, v72
    v_mfma_f32_16x16x32_bf16 v[228:231], a[184:187], v[100:103], v[228:231]
    ds_read_b128 a[80:83], v16 offset:36864
    v_mfma_f32_16x16x32_bf16 v[244:247], a[156:159], v[96:99], v[244:247]
    v_exp_f32 v73, v73
    v_mfma_f32_16x16x32_bf16 v[244:247], a[188:191], v[100:103], v[244:247]
    ds_read_b128 a[84:87], v17 offset:36864
    v_mfma_f32_16x16x32_bf16 v[108:111], v[120:123], v[100:103], v[108:111]
    v_exp_f32 v74, v74
    v_mfma_f32_16x16x32_bf16 v[80:83], a[96:99], a[48:51], v[52:55]
    ds_read_b128 a[88:91], v18 offset:36864
    v_cvt_pk_bf16_f32 v96, v72, v73
    v_mfma_f32_16x16x32_bf16 v[80:83], a[100:103], a[52:55], v[80:83]
    v_exp_f32 v75, v75
    v_mfma_f32_16x16x32_bf16 v[80:83], a[104:107], a[56:59], v[80:83]
    buffer_load_dwordx4 v10, s[8:11], s32 offen offset:2048 nt lds
    v_mfma_f32_16x16x32_bf16 v[80:83], a[108:111], a[60:63], v[80:83]
    v_exp_f32 v76, v76
    v_mfma_f32_16x16x32_bf16 v[84:87], a[112:115], a[48:51], v[52:55]
    ds_read_b128 a[92:95], v19 offset:36864
    v_cvt_pk_bf16_f32 v97, v74, v75
    v_mfma_f32_16x16x32_bf16 v[84:87], a[116:119], a[52:55], v[84:87]
    v_exp_f32 v77, v77
    v_mfma_f32_16x16x32_bf16 v[84:87], a[120:123], a[56:59], v[84:87]
    ds_read_b128 a[96:99], v16 offset:49152
    v_mfma_f32_16x16x32_bf16 v[84:87], a[124:127], a[60:63], v[84:87]
    v_exp_f32 v78, v78
    v_mfma_f32_16x16x32_bf16 v[136:139], a[128:131], v[88:91], v[136:139]
    ds_read_b128 a[100:103], v17 offset:49152
    v_cvt_pk_bf16_f32 v98, v76, v77
    v_mfma_f32_16x16x32_bf16 v[136:139], a[160:163], v[92:95], v[136:139]
    v_exp_f32 v79, v79
    v_mfma_f32_16x16x32_bf16 v[152:155], a[132:135], v[88:91], v[152:155]
    buffer_load_dwordx4 v11, s[8:11], s32 offen offset:3072 nt lds
    v_mfma_f32_16x16x32_bf16 v[152:155], a[164:167], v[92:95], v[152:155]
    ds_read_b128 a[104:107], v18 offset:49152
    v_cvt_pk_bf16_f32 v99, v78, v79
    v_mfma_f32_16x16x32_bf16 v[168:171], a[136:139], v[88:91], v[168:171]
    v_exp_f32 v80, v80
    v_mfma_f32_16x16x32_bf16 v[168:171], a[168:171], v[92:95], v[168:171]
    ds_read_b128 a[108:111], v19 offset:49152
    v_mfma_f32_16x16x32_bf16 v[184:187], a[140:143], v[88:91], v[184:187]
    v_exp_f32 v81, v81
    v_mfma_f32_16x16x32_bf16 v[184:187], a[172:175], v[92:95], v[184:187]
    v_mfma_f32_16x16x32_bf16 v[112:115], v[120:123], v[88:91], v[112:115]
    s_waitcnt lgkmcnt(2)
    v_exp_f32 v82, v82
    v_mfma_f32_16x16x32_bf16 v[56:59], a[64:67], a[0:3], v[40:43]
    s_xor_b32 s32, s30, s39
    ds_read_b128 a[112:115], v16 offset:53248
    v_cvt_pk_bf16_f32 v100, v80, v81
    v_mfma_f32_16x16x32_bf16 v[56:59], a[68:71], a[4:7], v[56:59]
    s_add_u32 m0, s33, 98304
    v_exp_f32 v83, v83
    v_mfma_f32_16x16x32_bf16 v[56:59], a[72:75], a[8:11], v[56:59]
    buffer_load_dwordx4 v12, s[12:15], s32 offen offset:0 nt lds
    v_mfma_f32_16x16x32_bf16 v[56:59], a[76:79], a[12:15], v[56:59]
    s_add_u32 s30, s30, 16384
    v_exp_f32 v84, v84
    v_mfma_f32_16x16x32_bf16 v[60:63], a[80:83], a[0:3], v[40:43]
    ds_read_b128 a[116:119], v17 offset:53248
    v_cvt_pk_bf16_f32 v101, v82, v83
    v_mfma_f32_16x16x32_bf16 v[60:63], a[84:87], a[4:7], v[60:63]
    v_exp_f32 v85, v85
    v_mfma_f32_16x16x32_bf16 v[60:63], a[88:91], a[8:11], v[60:63]
    ds_read_b128 a[120:123], v18 offset:53248
    v_mfma_f32_16x16x32_bf16 v[60:63], a[92:95], a[12:15], v[60:63]
    v_exp_f32 v86, v86
    v_mfma_f32_16x16x32_bf16 v[200:203], a[144:147], v[88:91], v[200:203]
    ds_read_b128 a[124:127], v19 offset:53248
    v_cvt_pk_bf16_f32 v102, v84, v85
    v_mfma_f32_16x16x32_bf16 v[200:203], a[176:179], v[92:95], v[200:203]
    v_exp_f32 v87, v87
    v_mfma_f32_16x16x32_bf16 v[216:219], a[148:151], v[88:91], v[216:219]
    buffer_load_dwordx4 v13, s[12:15], s32 offen offset:1024 nt lds
    v_mfma_f32_16x16x32_bf16 v[216:219], a[180:183], v[92:95], v[216:219]
    v_cvt_pk_bf16_f32 v103, v86, v87
    v_mfma_f32_16x16x32_bf16 v[232:235], a[152:155], v[88:91], v[232:235]
    v_exp_f32 v56, v56
    v_mfma_f32_16x16x32_bf16 v[232:235], a[184:187], v[92:95], v[232:235]
    v_mfma_f32_16x16x32_bf16 v[248:251], a[156:159], v[88:91], v[248:251]
    v_exp_f32 v57, v57
    v_mfma_f32_16x16x32_bf16 v[248:251], a[188:191], v[92:95], v[248:251]
    v_mfma_f32_16x16x32_bf16 v[112:115], v[120:123], v[92:95], v[112:115]
    v_exp_f32 v58, v58
    v_mfma_f32_16x16x32_bf16 v[64:67], a[96:99], a[0:3], v[40:43]
    v_cvt_pk_bf16_f32 v88, v56, v57
    v_mfma_f32_16x16x32_bf16 v[64:67], a[100:103], a[4:7], v[64:67]
    s_waitcnt lgkmcnt(0)
    v_exp_f32 v59, v59
    v_mfma_f32_16x16x32_bf16 v[64:67], a[104:107], a[8:11], v[64:67]
    buffer_load_dwordx4 v12, s[12:15], s32 offen offset:2048 nt lds
    v_mfma_f32_16x16x32_bf16 v[64:67], a[108:111], a[12:15], v[64:67]
    v_exp_f32 v60, v60
    v_mfma_f32_16x16x32_bf16 v[68:71], a[112:115], a[0:3], v[40:43]
    v_cvt_pk_bf16_f32 v89, v58, v59
    v_mfma_f32_16x16x32_bf16 v[68:71], a[116:119], a[4:7], v[68:71]
    v_exp_f32 v61, v61
    v_mfma_f32_16x16x32_bf16 v[68:71], a[120:123], a[8:11], v[68:71]
    v_mfma_f32_16x16x32_bf16 v[68:71], a[124:127], a[12:15], v[68:71]
    v_exp_f32 v62, v62
    v_mfma_f32_16x16x32_bf16 v[140:143], a[128:131], v[96:99], v[140:143]
    v_cvt_pk_bf16_f32 v90, v60, v61
    v_mfma_f32_16x16x32_bf16 v[140:143], a[160:163], v[100:103], v[140:143]
    v_exp_f32 v63, v63
    v_mfma_f32_16x16x32_bf16 v[156:159], a[132:135], v[96:99], v[156:159]
    buffer_load_dwordx4 v13, s[12:15], s32 offen offset:3072 nt lds
    v_mfma_f32_16x16x32_bf16 v[156:159], a[164:167], v[100:103], v[156:159]
    v_cvt_pk_bf16_f32 v91, v62, v63
    v_mfma_f32_16x16x32_bf16 v[172:175], a[136:139], v[96:99], v[172:175]
    s_waitcnt vmcnt(12)
    v_exp_f32 v64, v64
    v_mfma_f32_16x16x32_bf16 v[172:175], a[168:171], v[100:103], v[172:175]
    s_barrier
    ds_read_b64_tr_b16 a[128:129], v20 offset:32768
    ds_read_b64_tr_b16 a[130:131], v20 offset:36864
    v_mfma_f32_16x16x32_bf16 v[188:191], a[140:143], v[96:99], v[188:191]
    v_exp_f32 v65, v65
    v_mfma_f32_16x16x32_bf16 v[188:191], a[172:175], v[100:103], v[188:191]
    ds_read_b64_tr_b16 a[160:161], v20 offset:49152
    ds_read_b64_tr_b16 a[162:163], v20 offset:53248
    v_mfma_f32_16x16x32_bf16 v[116:119], v[120:123], v[96:99], v[116:119]
    v_exp_f32 v66, v66
    v_mfma_f32_16x16x32_bf16 v[72:75], a[64:67], a[16:19], v[44:47]
    s_xor_b32 s32, s30, s39
    ds_read_b64_tr_b16 a[132:133], v21 offset:32768
    v_cvt_pk_bf16_f32 v92, v64, v65
    v_mfma_f32_16x16x32_bf16 v[72:75], a[68:71], a[20:23], v[72:75]
    s_add_u32 m0, s33, 114688
    v_exp_f32 v67, v67
    v_mfma_f32_16x16x32_bf16 v[72:75], a[72:75], a[24:27], v[72:75]
    buffer_load_dwordx4 v12, s[12:15], s32 offen offset:0 nt lds
    ds_read_b64_tr_b16 a[134:135], v21 offset:36864
    v_mfma_f32_16x16x32_bf16 v[72:75], a[76:79], a[28:31], v[72:75]
    s_add_u32 s30, s30, 16384
    v_exp_f32 v68, v68
    v_mfma_f32_16x16x32_bf16 v[76:79], a[80:83], a[16:19], v[44:47]
    ds_read_b64_tr_b16 a[164:165], v21 offset:49152
    v_cvt_pk_bf16_f32 v93, v66, v67
    v_mfma_f32_16x16x32_bf16 v[76:79], a[84:87], a[20:23], v[76:79]
    v_exp_f32 v69, v69
    v_mfma_f32_16x16x32_bf16 v[76:79], a[88:91], a[24:27], v[76:79]
    ds_read_b64_tr_b16 a[166:167], v21 offset:53248
    ds_read_b64_tr_b16 a[136:137], v22 offset:32768
    v_mfma_f32_16x16x32_bf16 v[76:79], a[92:95], a[28:31], v[76:79]
    v_exp_f32 v70, v70
    v_mfma_f32_16x16x32_bf16 v[204:207], a[144:147], v[96:99], v[204:207]
    ds_read_b64_tr_b16 a[138:139], v22 offset:36864
    v_cvt_pk_bf16_f32 v94, v68, v69
    v_mfma_f32_16x16x32_bf16 v[204:207], a[176:179], v[100:103], v[204:207]
    v_exp_f32 v71, v71
    v_mfma_f32_16x16x32_bf16 v[220:223], a[148:151], v[96:99], v[220:223]
    buffer_load_dwordx4 v13, s[12:15], s32 offen offset:1024 nt lds
    ds_read_b64_tr_b16 a[168:169], v22 offset:49152
    v_mfma_f32_16x16x32_bf16 v[220:223], a[180:183], v[100:103], v[220:223]
    ds_read_b64_tr_b16 a[170:171], v22 offset:53248
    v_cvt_pk_bf16_f32 v95, v70, v71
    v_mfma_f32_16x16x32_bf16 v[236:239], a[152:155], v[96:99], v[236:239]
    v_exp_f32 v72, v72
    v_mfma_f32_16x16x32_bf16 v[236:239], a[184:187], v[100:103], v[236:239]
    ds_read_b64_tr_b16 a[140:141], v23 offset:32768
    ds_read_b64_tr_b16 a[142:143], v23 offset:36864
    v_mfma_f32_16x16x32_bf16 v[252:255], a[156:159], v[96:99], v[252:255]
    v_exp_f32 v73, v73
    v_mfma_f32_16x16x32_bf16 v[252:255], a[188:191], v[100:103], v[252:255]
    ds_read_b64_tr_b16 a[172:173], v23 offset:49152
    ds_read_b64_tr_b16 a[174:175], v23 offset:53248
    v_mfma_f32_16x16x32_bf16 v[116:119], v[120:123], v[100:103], v[116:119]
    v_exp_f32 v74, v74
    v_mfma_f32_16x16x32_bf16 v[80:83], a[96:99], a[16:19], v[44:47]
    ds_read_b64_tr_b16 a[144:145], v24 offset:32768
    v_cvt_pk_bf16_f32 v96, v72, v73
    v_mfma_f32_16x16x32_bf16 v[80:83], a[100:103], a[20:23], v[80:83]
    v_exp_f32 v75, v75
    v_mfma_f32_16x16x32_bf16 v[80:83], a[104:107], a[24:27], v[80:83]
    buffer_load_dwordx4 v12, s[12:15], s32 offen offset:2048 nt lds
    ds_read_b64_tr_b16 a[146:147], v24 offset:36864
    v_mfma_f32_16x16x32_bf16 v[80:83], a[108:111], a[28:31], v[80:83]
    v_exp_f32 v76, v76
    v_mfma_f32_16x16x32_bf16 v[84:87], a[112:115], a[16:19], v[44:47]
    ds_read_b64_tr_b16 a[176:177], v24 offset:49152
    v_cvt_pk_bf16_f32 v97, v74, v75
    v_mfma_f32_16x16x32_bf16 v[84:87], a[116:119], a[20:23], v[84:87]
    v_exp_f32 v77, v77
    v_mfma_f32_16x16x32_bf16 v[84:87], a[120:123], a[24:27], v[84:87]
    ds_read_b64_tr_b16 a[178:179], v24 offset:53248
    ds_read_b64_tr_b16 a[148:149], v25 offset:32768
    v_mfma_f32_16x16x32_bf16 v[84:87], a[124:127], a[28:31], v[84:87]
    s_waitcnt lgkmcnt(5)
    v_exp_f32 v78, v78
    v_mfma_f32_16x16x32_bf16 v[128:131], a[128:131], v[88:91], v[128:131]
    ds_read_b64_tr_b16 a[150:151], v25 offset:36864
    v_cvt_pk_bf16_f32 v98, v76, v77
    v_mfma_f32_16x16x32_bf16 v[128:131], a[160:163], v[92:95], v[128:131]
    v_exp_f32 v79, v79
    v_mfma_f32_16x16x32_bf16 v[144:147], a[132:135], v[88:91], v[144:147]
    buffer_load_dwordx4 v13, s[12:15], s32 offen offset:3072 nt lds
    ds_read_b64_tr_b16 a[180:181], v25 offset:49152
    v_mfma_f32_16x16x32_bf16 v[144:147], a[164:167], v[92:95], v[144:147]
    ds_read_b64_tr_b16 a[182:183], v25 offset:53248
    v_cvt_pk_bf16_f32 v99, v78, v79
    v_mfma_f32_16x16x32_bf16 v[160:163], a[136:139], v[88:91], v[160:163]
    v_exp_f32 v80, v80
    v_mfma_f32_16x16x32_bf16 v[160:163], a[168:171], v[92:95], v[160:163]
    ds_read_b64_tr_b16 a[152:153], v26 offset:32768
    ds_read_b64_tr_b16 a[154:155], v26 offset:36864
    v_mfma_f32_16x16x32_bf16 v[176:179], a[140:143], v[88:91], v[176:179]
    v_exp_f32 v81, v81
    v_mfma_f32_16x16x32_bf16 v[176:179], a[172:175], v[92:95], v[176:179]
    ds_read_b64_tr_b16 a[184:185], v26 offset:49152
    ds_read_b64_tr_b16 a[186:187], v26 offset:53248
    v_mfma_f32_16x16x32_bf16 v[104:107], v[120:123], v[88:91], v[104:107]
    v_exp_f32 v82, v82
    v_mfma_f32_16x16x32_bf16 v[56:59], a[64:67], a[32:35], v[48:51]
    s_xor_b32 s32, s38, s39
    ds_read_b64_tr_b16 a[156:157], v27 offset:32768
    v_cvt_pk_bf16_f32 v100, v80, v81
    v_mfma_f32_16x16x32_bf16 v[56:59], a[68:71], a[36:39], v[56:59]
    s_add_u32 m0, s33, 65536
    v_exp_f32 v83, v83
    v_mfma_f32_16x16x32_bf16 v[56:59], a[72:75], a[40:43], v[56:59]
    buffer_load_dwordx4 v8, s[8:11], s32 offen offset:0 nt lds
    ds_read_b64_tr_b16 a[158:159], v27 offset:36864
    v_mfma_f32_16x16x32_bf16 v[56:59], a[76:79], a[44:47], v[56:59]
    s_add_u32 s38, s38, 16384
    v_exp_f32 v84, v84
    v_mfma_f32_16x16x32_bf16 v[60:63], a[80:83], a[32:35], v[48:51]
    ds_read_b64_tr_b16 a[188:189], v27 offset:49152
    v_cvt_pk_bf16_f32 v101, v82, v83
    v_mfma_f32_16x16x32_bf16 v[60:63], a[84:87], a[36:39], v[60:63]
    v_exp_f32 v85, v85
    v_mfma_f32_16x16x32_bf16 v[60:63], a[88:91], a[40:43], v[60:63]
    ds_read_b64_tr_b16 a[190:191], v27 offset:53248
    v_mfma_f32_16x16x32_bf16 v[60:63], a[92:95], a[44:47], v[60:63]
    s_waitcnt lgkmcnt(4)
    v_exp_f32 v86, v86
    v_mfma_f32_16x16x32_bf16 v[192:195], a[144:147], v[88:91], v[192:195]
    v_cvt_pk_bf16_f32 v102, v84, v85
    v_mfma_f32_16x16x32_bf16 v[192:195], a[176:179], v[92:95], v[192:195]
    v_exp_f32 v87, v87
    v_mfma_f32_16x16x32_bf16 v[208:211], a[148:151], v[88:91], v[208:211]
    buffer_load_dwordx4 v9, s[8:11], s32 offen offset:1024 nt lds
    v_mfma_f32_16x16x32_bf16 v[208:211], a[180:183], v[92:95], v[208:211]
    v_cvt_pk_bf16_f32 v103, v86, v87
    v_mfma_f32_16x16x32_bf16 v[224:227], a[152:155], v[88:91], v[224:227]
    v_exp_f32 v56, v56
    v_mfma_f32_16x16x32_bf16 v[224:227], a[184:187], v[92:95], v[224:227]
    s_waitcnt lgkmcnt(1)
    v_mfma_f32_16x16x32_bf16 v[240:243], a[156:159], v[88:91], v[240:243]
    s_waitcnt lgkmcnt(0)
    v_exp_f32 v57, v57
    v_mfma_f32_16x16x32_bf16 v[240:243], a[188:191], v[92:95], v[240:243]
    v_mfma_f32_16x16x32_bf16 v[104:107], v[120:123], v[92:95], v[104:107]
    v_exp_f32 v58, v58
    v_mfma_f32_16x16x32_bf16 v[64:67], a[96:99], a[32:35], v[48:51]
    v_cvt_pk_bf16_f32 v88, v56, v57
    v_mfma_f32_16x16x32_bf16 v[64:67], a[100:103], a[36:39], v[64:67]
    v_exp_f32 v59, v59
    v_mfma_f32_16x16x32_bf16 v[64:67], a[104:107], a[40:43], v[64:67]
    buffer_load_dwordx4 v10, s[8:11], s32 offen offset:2048 nt lds
    v_mfma_f32_16x16x32_bf16 v[64:67], a[108:111], a[44:47], v[64:67]
    v_exp_f32 v60, v60
    v_mfma_f32_16x16x32_bf16 v[68:71], a[112:115], a[32:35], v[48:51]
    v_cvt_pk_bf16_f32 v89, v58, v59
    v_mfma_f32_16x16x32_bf16 v[68:71], a[116:119], a[36:39], v[68:71]
    v_exp_f32 v61, v61
    v_mfma_f32_16x16x32_bf16 v[68:71], a[120:123], a[40:43], v[68:71]
    v_mfma_f32_16x16x32_bf16 v[68:71], a[124:127], a[44:47], v[68:71]
    v_exp_f32 v62, v62
    v_mfma_f32_16x16x32_bf16 v[132:135], a[128:131], v[96:99], v[132:135]
    v_cvt_pk_bf16_f32 v90, v60, v61
    v_mfma_f32_16x16x32_bf16 v[132:135], a[160:163], v[100:103], v[132:135]
    v_exp_f32 v63, v63
    v_mfma_f32_16x16x32_bf16 v[148:151], a[132:135], v[96:99], v[148:151]
    buffer_load_dwordx4 v11, s[8:11], s32 offen offset:3072 nt lds
    v_mfma_f32_16x16x32_bf16 v[148:151], a[164:167], v[100:103], v[148:151]
    v_cvt_pk_bf16_f32 v91, v62, v63
    v_mfma_f32_16x16x32_bf16 v[164:167], a[136:139], v[96:99], v[164:167]
    s_waitcnt vmcnt(12)
    v_exp_f32 v64, v64
    v_mfma_f32_16x16x32_bf16 v[164:167], a[168:171], v[100:103], v[164:167]
    s_barrier
    v_mfma_f32_16x16x32_bf16 v[180:183], a[140:143], v[96:99], v[180:183]
    v_exp_f32 v65, v65
    v_mfma_f32_16x16x32_bf16 v[180:183], a[172:175], v[100:103], v[180:183]
    v_mfma_f32_16x16x32_bf16 v[108:111], v[120:123], v[96:99], v[108:111]
    v_exp_f32 v66, v66
    v_mfma_f32_16x16x32_bf16 v[72:75], a[64:67], a[48:51], v[52:55]
    s_xor_b32 s32, s38, s39
    v_cvt_pk_bf16_f32 v92, v64, v65
    v_mfma_f32_16x16x32_bf16 v[72:75], a[68:71], a[52:55], v[72:75]
    s_add_u32 m0, s33, 81920
    v_exp_f32 v67, v67
    v_mfma_f32_16x16x32_bf16 v[72:75], a[72:75], a[56:59], v[72:75]
    buffer_load_dwordx4 v8, s[8:11], s32 offen offset:0 nt lds
    v_mfma_f32_16x16x32_bf16 v[72:75], a[76:79], a[60:63], v[72:75]
    s_add_u32 s38, s38, 16384
    v_exp_f32 v68, v68
    v_mfma_f32_16x16x32_bf16 v[76:79], a[80:83], a[48:51], v[52:55]
    ds_read_b128 a[64:67], v16 offset:0
    v_cvt_pk_bf16_f32 v93, v66, v67
    v_mfma_f32_16x16x32_bf16 v[76:79], a[84:87], a[52:55], v[76:79]
    v_exp_f32 v69, v69
    v_mfma_f32_16x16x32_bf16 v[76:79], a[88:91], a[56:59], v[76:79]
    ds_read_b128 a[68:71], v17 offset:0
    v_mfma_f32_16x16x32_bf16 v[76:79], a[92:95], a[60:63], v[76:79]
    v_exp_f32 v70, v70
    v_mfma_f32_16x16x32_bf16 v[196:199], a[144:147], v[96:99], v[196:199]
    ds_read_b128 a[72:75], v18 offset:0
    v_cvt_pk_bf16_f32 v94, v68, v69
    v_mfma_f32_16x16x32_bf16 v[196:199], a[176:179], v[100:103], v[196:199]
    v_exp_f32 v71, v71
    v_mfma_f32_16x16x32_bf16 v[212:215], a[148:151], v[96:99], v[212:215]
    buffer_load_dwordx4 v9, s[8:11], s32 offen offset:1024 nt lds
    v_mfma_f32_16x16x32_bf16 v[212:215], a[180:183], v[100:103], v[212:215]
    ds_read_b128 a[76:79], v19 offset:0
    v_cvt_pk_bf16_f32 v95, v70, v71
    v_mfma_f32_16x16x32_bf16 v[228:231], a[152:155], v[96:99], v[228:231]
    v_exp_f32 v72, v72
    v_mfma_f32_16x16x32_bf16 v[228:231], a[184:187], v[100:103], v[228:231]
    ds_read_b128 a[80:83], v16 offset:4096
    v_mfma_f32_16x16x32_bf16 v[244:247], a[156:159], v[96:99], v[244:247]
    v_exp_f32 v73, v73
    v_mfma_f32_16x16x32_bf16 v[244:247], a[188:191], v[100:103], v[244:247]
    ds_read_b128 a[84:87], v17 offset:4096
    v_mfma_f32_16x16x32_bf16 v[108:111], v[120:123], v[100:103], v[108:111]
    v_exp_f32 v74, v74
    v_mfma_f32_16x16x32_bf16 v[80:83], a[96:99], a[48:51], v[52:55]
    ds_read_b128 a[88:91], v18 offset:4096
    v_cvt_pk_bf16_f32 v96, v72, v73
    v_mfma_f32_16x16x32_bf16 v[80:83], a[100:103], a[52:55], v[80:83]
    v_exp_f32 v75, v75
    v_mfma_f32_16x16x32_bf16 v[80:83], a[104:107], a[56:59], v[80:83]
    buffer_load_dwordx4 v10, s[8:11], s32 offen offset:2048 nt lds
    v_mfma_f32_16x16x32_bf16 v[80:83], a[108:111], a[60:63], v[80:83]
    v_exp_f32 v76, v76
    v_mfma_f32_16x16x32_bf16 v[84:87], a[112:115], a[48:51], v[52:55]
    ds_read_b128 a[92:95], v19 offset:4096
    v_cvt_pk_bf16_f32 v97, v74, v75
    v_mfma_f32_16x16x32_bf16 v[84:87], a[116:119], a[52:55], v[84:87]
    v_exp_f32 v77, v77
    v_mfma_f32_16x16x32_bf16 v[84:87], a[120:123], a[56:59], v[84:87]
    ds_read_b128 a[96:99], v16 offset:16384
    v_mfma_f32_16x16x32_bf16 v[84:87], a[124:127], a[60:63], v[84:87]
    v_exp_f32 v78, v78
    v_mfma_f32_16x16x32_bf16 v[136:139], a[128:131], v[88:91], v[136:139]
    ds_read_b128 a[100:103], v17 offset:16384
    v_cvt_pk_bf16_f32 v98, v76, v77
    v_mfma_f32_16x16x32_bf16 v[136:139], a[160:163], v[92:95], v[136:139]
    s_add_u32 s31, s31, 1
    v_exp_f32 v79, v79
    v_mfma_f32_16x16x32_bf16 v[152:155], a[132:135], v[88:91], v[152:155]
    buffer_load_dwordx4 v11, s[8:11], s32 offen offset:3072 nt lds
    v_mfma_f32_16x16x32_bf16 v[152:155], a[164:167], v[92:95], v[152:155]
    ds_read_b128 a[104:107], v18 offset:16384
    v_cvt_pk_bf16_f32 v99, v78, v79
    v_mfma_f32_16x16x32_bf16 v[168:171], a[136:139], v[88:91], v[168:171]
    v_exp_f32 v80, v80
    v_mfma_f32_16x16x32_bf16 v[168:171], a[168:171], v[92:95], v[168:171]
    ds_read_b128 a[108:111], v19 offset:16384
    v_mfma_f32_16x16x32_bf16 v[184:187], a[140:143], v[88:91], v[184:187]
    s_cmp_lt_u32 s31, 6
    v_exp_f32 v81, v81
    v_mfma_f32_16x16x32_bf16 v[184:187], a[172:175], v[92:95], v[184:187]
    s_cbranch_scc1 L_loop
    v_mfma_f32_16x16x32_bf16 v[112:115], v[120:123], v[88:91], v[112:115]
    s_waitcnt lgkmcnt(2)
    v_exp_f32 v82, v82
    v_mfma_f32_16x16x32_bf16 v[56:59], a[64:67], a[0:3], v[40:43]
    s_xor_b32 s32, s30, s39
    ds_read_b128 a[112:115], v16 offset:20480
    v_cvt_pk_bf16_f32 v100, v80, v81
    v_mfma_f32_16x16x32_bf16 v[56:59], a[68:71], a[4:7], v[56:59]
    s_add_u32 m0, s33, 131072
    v_exp_f32 v83, v83
    v_mfma_f32_16x16x32_bf16 v[56:59], a[72:75], a[8:11], v[56:59]
    buffer_load_dwordx4 v12, s[12:15], s32 offen offset:0 nt lds
    v_mfma_f32_16x16x32_bf16 v[56:59], a[76:79], a[12:15], v[56:59]
    s_add_u32 s30, s30, 16384
    v_exp_f32 v84, v84
    v_mfma_f32_16x16x32_bf16 v[60:63], a[80:83], a[0:3], v[40:43]
    ds_read_b128 a[116:119], v17 offset:20480
    v_cvt_pk_bf16_f32 v101, v82, v83
    v_mfma_f32_16x16x32_bf16 v[60:63], a[84:87], a[4:7], v[60:63]
    v_exp_f32 v85, v85
    v_mfma_f32_16x16x32_bf16 v[60:63], a[88:91], a[8:11], v[60:63]
    ds_read_b128 a[120:123], v18 offset:20480
    v_lshlrev_b32 v15, 8, v1
    v_mfma_f32_16x16x32_bf16 v[60:63], a[92:95], a[12:15], v[60:63]
    v_exp_f32 v86, v86
    v_mfma_f32_16x16x32_bf16 v[200:203], a[144:147], v[88:91], v[200:203]
    ds_read_b128 a[124:127], v19 offset:20480
    v_cvt_pk_bf16_f32 v102, v84, v85
    v_mfma_f32_16x16x32_bf16 v[200:203], a[176:179], v[92:95], v[200:203]
    v_exp_f32 v87, v87
    v_mfma_f32_16x16x32_bf16 v[216:219], a[148:151], v[88:91], v[216:219]
    buffer_load_dwordx4 v13, s[12:15], s32 offen offset:1024 nt lds
    v_mfma_f32_16x16x32_bf16 v[216:219], a[180:183], v[92:95], v[216:219]
    v_cvt_pk_bf16_f32 v103, v86, v87
    v_cmp_eq_u32 vcc, 0, v1
    v_mfma_f32_16x16x32_bf16 v[232:235], a[152:155], v[88:91], v[232:235]
    s_waitcnt vmcnt(14)
    v_exp_f32 v56, v56
    v_mfma_f32_16x16x32_bf16 v[232:235], a[184:187], v[92:95], v[232:235]
    s_barrier
    ds_read_b64_tr_b16 a[192:193], v20 offset:0
    v_mov_b32 v34, 1
    v_mfma_f32_16x16x32_bf16 v[248:251], a[156:159], v[88:91], v[248:251]
    v_exp_f32 v57, v57
    v_mfma_f32_16x16x32_bf16 v[248:251], a[188:191], v[92:95], v[248:251]
    ds_read_b64_tr_b16 a[194:195], v20 offset:4096
    ds_read_b64_tr_b16 a[196:197], v21 offset:0
    v_mfma_f32_16x16x32_bf16 v[112:115], v[120:123], v[92:95], v[112:115]
    v_exp_f32 v58, v58
    v_mfma_f32_16x16x32_bf16 v[64:67], a[64:67], a[16:19], v[44:47]
    ds_read_b64_tr_b16 a[198:199], v21 offset:4096
    v_cvt_pk_bf16_f32 v88, v56, v57
    v_mfma_f32_16x16x32_bf16 v[64:67], a[68:71], a[20:23], v[64:67]
    v_exp_f32 v59, v59
    v_mfma_f32_16x16x32_bf16 v[64:67], a[72:75], a[24:27], v[64:67]
    buffer_load_dwordx4 v12, s[12:15], s32 offen offset:2048 nt lds
    v_mfma_f32_16x16x32_bf16 v[64:67], a[76:79], a[28:31], v[64:67]
    v_exp_f32 v60, v60
    v_mfma_f32_16x16x32_bf16 v[68:71], a[80:83], a[16:19], v[44:47]
    ds_read_b64_tr_b16 a[200:201], v22 offset:0
    v_cvt_pk_bf16_f32 v89, v58, v59
    v_mfma_f32_16x16x32_bf16 v[68:71], a[84:87], a[20:23], v[68:71]
    v_exp_f32 v61, v61
    v_mfma_f32_16x16x32_bf16 v[68:71], a[88:91], a[24:27], v[68:71]
    ds_read_b64_tr_b16 a[202:203], v22 offset:4096
    ds_read_b64_tr_b16 a[204:205], v23 offset:0
    v_mfma_f32_16x16x32_bf16 v[68:71], a[92:95], a[28:31], v[68:71]
    v_exp_f32 v62, v62
    v_mfma_f32_16x16x32_bf16 v[140:143], a[128:131], v[96:99], v[140:143]
    ds_read_b64_tr_b16 a[206:207], v23 offset:4096
    v_cvt_pk_bf16_f32 v90, v60, v61
    v_mfma_f32_16x16x32_bf16 v[140:143], a[160:163], v[100:103], v[140:143]
    v_exp_f32 v63, v63
    v_mfma_f32_16x16x32_bf16 v[156:159], a[132:135], v[96:99], v[156:159]
    buffer_load_dwordx4 v13, s[12:15], s32 offen offset:3072 nt lds
    v_mfma_f32_16x16x32_bf16 v[156:159], a[164:167], v[100:103], v[156:159]
    ds_read_b64_tr_b16 a[208:209], v24 offset:0
    v_cvt_pk_bf16_f32 v91, v62, v63
    v_mfma_f32_16x16x32_bf16 v[172:175], a[136:139], v[96:99], v[172:175]
    v_exp_f32 v64, v64
    v_mfma_f32_16x16x32_bf16 v[172:175], a[168:171], v[100:103], v[172:175]
    ds_read_b64_tr_b16 a[210:211], v24 offset:4096
    ds_read_b64_tr_b16 a[212:213], v25 offset:0
    v_mfma_f32_16x16x32_bf16 v[188:191], a[140:143], v[96:99], v[188:191]
    v_exp_f32 v65, v65
    v_mfma_f32_16x16x32_bf16 v[188:191], a[172:175], v[100:103], v[188:191]
    ds_read_b64_tr_b16 a[214:215], v25 offset:4096
    ds_read_b64_tr_b16 a[216:217], v26 offset:0
    v_mfma_f32_16x16x32_bf16 v[116:119], v[120:123], v[96:99], v[116:119]
    v_exp_f32 v66, v66
    v_mfma_f32_16x16x32_bf16 v[204:207], a[144:147], v[96:99], v[204:207]
    v_mfma_f32_16x16x32_bf16 v[204:207], a[176:179], v[100:103], v[204:207]
    v_mfma_f32_16x16x32_bf16 v[220:223], a[148:151], v[96:99], v[220:223]
    v_mfma_f32_16x16x32_bf16 v[220:223], a[180:183], v[100:103], v[220:223]
    v_mfma_f32_16x16x32_bf16 v[236:239], a[152:155], v[96:99], v[236:239]
    v_mfma_f32_16x16x32_bf16 v[236:239], a[184:187], v[100:103], v[236:239]
    v_mfma_f32_16x16x32_bf16 v[252:255], a[156:159], v[96:99], v[252:255]
    v_mfma_f32_16x16x32_bf16 v[252:255], a[188:191], v[100:103], v[252:255]
    v_mfma_f32_16x16x32_bf16 v[116:119], v[120:123], v[100:103], v[116:119]
    v_mfma_f32_16x16x32_bf16 v[72:75], a[64:67], a[32:35], v[48:51]
    s_xor_b32 s32, s30, s39
    ds_read_b64_tr_b16 a[218:219], v26 offset:4096
    v_cvt_pk_bf16_f32 v92, v64, v65
    v_mfma_f32_16x16x32_bf16 v[72:75], a[68:71], a[36:39], v[72:75]
    s_add_u32 m0, s33, 147456
    v_exp_f32 v67, v67
    v_mfma_f32_16x16x32_bf16 v[72:75], a[72:75], a[40:43], v[72:75]
    buffer_load_dwordx4 v12, s[12:15], s32 offen offset:0 nt lds
    v_mfma_f32_16x16x32_bf16 v[72:75], a[76:79], a[44:47], v[72:75]
    s_add_u32 s30, s30, 16384
    v_exp_f32 v68, v68
    v_mfma_f32_16x16x32_bf16 v[76:79], a[80:83], a[32:35], v[48:51]
    ds_read_b64_tr_b16 a[220:221], v27 offset:0
    v_cvt_pk_bf16_f32 v93, v66, v67
    v_mfma_f32_16x16x32_bf16 v[76:79], a[84:87], a[36:39], v[76:79]
    v_exp_f32 v69, v69
    v_mfma_f32_16x16x32_bf16 v[76:79], a[88:91], a[40:43], v[76:79]
    ds_read_b64_tr_b16 a[222:223], v27 offset:4096
    v_cndmask_b32 v34, 0, v34, vcc
    v_mfma_f32_16x16x32_bf16 v[76:79], a[92:95], a[44:47], v[76:79]
    s_waitcnt lgkmcnt(3)
    v_exp_f32 v70, v70
    v_mfma_f32_16x16x32_bf16 v[128:131], a[192:195], v[88:91], v[128:131]
    v_cvt_pk_bf16_f32 v94, v68, v69
    v_xor_b32 v127, 0x2000, v126
    v_mfma_f32_16x16x32_bf16 v[144:147], a[196:199], v[88:91], v[144:147]
    v_exp_f32 v71, v71
    v_mfma_f32_16x16x32_bf16 v[160:163], a[200:203], v[88:91], v[160:163]
    buffer_load_dwordx4 v13, s[12:15], s32 offen offset:1024 nt lds
    v_mfma_f32_16x16x32_bf16 v[176:179], a[204:207], v[88:91], v[176:179]
    v_cvt_pk_bf16_f32 v95, v70, v71
    v_mfma_f32_16x16x32_bf16 v[192:195], a[208:211], v[88:91], v[192:195]
    v_exp_f32 v72, v72
    v_mfma_f32_16x16x32_bf16 v[208:211], a[212:215], v[88:91], v[208:211]
    s_waitcnt lgkmcnt(1)
    v_mfma_f32_16x16x32_bf16 v[224:227], a[216:219], v[88:91], v[224:227]
    s_waitcnt lgkmcnt(0)
    v_exp_f32 v73, v73
    v_mfma_f32_16x16x32_bf16 v[240:243], a[220:223], v[88:91], v[240:243]
    v_mfma_f32_16x16x32_bf16 v[104:107], v[120:123], v[88:91], v[104:107]
    v_exp_f32 v74, v74
    v_mfma_f32_16x16x32_bf16 v[80:83], a[64:67], a[48:51], v[52:55]
    v_cvt_pk_bf16_f32 v96, v72, v73
    v_mfma_f32_16x16x32_bf16 v[80:83], a[68:71], a[52:55], v[80:83]
    v_exp_f32 v75, v75
    v_mfma_f32_16x16x32_bf16 v[80:83], a[72:75], a[56:59], v[80:83]
    buffer_load_dwordx4 v12, s[12:15], s32 offen offset:2048 nt lds
    v_mfma_f32_16x16x32_bf16 v[80:83], a[76:79], a[60:63], v[80:83]
    v_exp_f32 v76, v76
    v_mfma_f32_16x16x32_bf16 v[84:87], a[80:83], a[48:51], v[52:55]
    v_cvt_pk_bf16_f32 v97, v74, v75
    v_mfma_f32_16x16x32_bf16 v[84:87], a[84:87], a[52:55], v[84:87]
    v_exp_f32 v77, v77
    v_mfma_f32_16x16x32_bf16 v[84:87], a[88:91], a[56:59], v[84:87]
    v_mfma_f32_16x16x32_bf16 v[84:87], a[92:95], a[60:63], v[84:87]
    v_exp_f32 v78, v78
    v_mfma_f32_16x16x32_bf16 v[132:135], a[192:195], v[92:95], v[132:135]
    v_cvt_pk_bf16_f32 v98, v76, v77
    v_mfma_f32_16x16x32_bf16 v[148:151], a[196:199], v[92:95], v[148:151]
    v_exp_f32 v79, v79
    v_mfma_f32_16x16x32_bf16 v[164:167], a[200:203], v[92:95], v[164:167]
    buffer_load_dwordx4 v13, s[12:15], s32 offen offset:3072 nt lds
    v_mfma_f32_16x16x32_bf16 v[180:183], a[204:207], v[92:95], v[180:183]
    v_cvt_pk_bf16_f32 v99, v78, v79
    v_mfma_f32_16x16x32_bf16 v[196:199], a[208:211], v[92:95], v[196:199]
    s_waitcnt vmcnt(12)
    v_exp_f32 v80, v80
    v_mfma_f32_16x16x32_bf16 v[212:215], a[212:215], v[92:95], v[212:215]
    s_waitcnt lgkmcnt(0)
    s_barrier
    v_mfma_f32_16x16x32_bf16 v[228:231], a[216:219], v[92:95], v[228:231]
    v_exp_f32 v81, v81
    v_mfma_f32_16x16x32_bf16 v[244:247], a[220:223], v[92:95], v[244:247]
    v_mfma_f32_16x16x32_bf16 v[108:111], v[120:123], v[92:95], v[108:111]
    v_exp_f32 v82, v82
    v_mfma_f32_16x16x32_bf16 v[56:59], a[96:99], a[0:3], v[40:43]
    s_add_u32 m0, s33, 0
    ds_read_b64_tr_b16 a[160:161], v20 offset:16384
    v_cvt_pk_bf16_f32 v100, v80, v81
    v_mfma_f32_16x16x32_bf16 v[56:59], a[100:103], a[4:7], v[56:59]
    s_xor_b32 s67, s46, 0
    v_exp_f32 v83, v83
    v_mfma_f32_16x16x32_bf16 v[56:59], a[104:107], a[8:11], v[56:59]
    buffer_load_dwordx4 v36, s[20:23], s67 offen offset:0 lds
    v_mfma_f32_16x16x32_bf16 v[56:59], a[108:111], a[12:15], v[56:59]
    v_exp_f32 v84, v84
    v_mfma_f32_16x16x32_bf16 v[60:63], a[112:115], a[0:3], v[40:43]
    ds_read_b64_tr_b16 a[162:163], v20 offset:20480
    v_cvt_pk_bf16_f32 v101, v82, v83
    v_mfma_f32_16x16x32_bf16 v[60:63], a[116:119], a[4:7], v[60:63]
    v_exp_f32 v85, v85
    v_mfma_f32_16x16x32_bf16 v[60:63], a[120:123], a[8:11], v[60:63]
    ds_read_b64_tr_b16 a[164:165], v21 offset:16384
    buffer_load_dwordx4 v37, s[20:23], s67 offen offset:1024 lds
    v_mfma_f32_16x16x32_bf16 v[60:63], a[124:127], a[12:15], v[60:63]
    v_exp_f32 v86, v86
    v_mfma_f32_16x16x32_bf16 v[136:139], a[192:195], v[96:99], v[136:139]
    ds_read_b64_tr_b16 a[166:167], v21 offset:20480
    v_cvt_pk_bf16_f32 v102, v84, v85
    v_mfma_f32_16x16x32_bf16 v[152:155], a[196:199], v[96:99], v[152:155]
    v_exp_f32 v87, v87
    v_mfma_f32_16x16x32_bf16 v[168:171], a[200:203], v[96:99], v[168:171]
    buffer_load_dwordx4 v38, s[20:23], s67 offen offset:2048 lds
    v_mfma_f32_16x16x32_bf16 v[184:187], a[204:207], v[96:99], v[184:187]
    ds_read_b64_tr_b16 a[168:169], v22 offset:16384
    v_cvt_pk_bf16_f32 v103, v86, v87
    v_mfma_f32_16x16x32_bf16 v[200:203], a[208:211], v[96:99], v[200:203]
    v_exp_f32 v56, v56
    v_mfma_f32_16x16x32_bf16 v[216:219], a[212:215], v[96:99], v[216:219]
    ds_read_b64_tr_b16 a[170:171], v22 offset:20480
    buffer_load_dwordx4 v39, s[20:23], s67 offen offset:3072 lds
    v_mfma_f32_16x16x32_bf16 v[232:235], a[216:219], v[96:99], v[232:235]
    v_exp_f32 v57, v57
    v_mfma_f32_16x16x32_bf16 v[248:251], a[220:223], v[96:99], v[248:251]
    ds_read_b64_tr_b16 a[172:173], v23 offset:16384
    v_mfma_f32_16x16x32_bf16 v[112:115], v[120:123], v[96:99], v[112:115]
    s_add_u32 m0, s33, 16384
    v_exp_f32 v58, v58
    v_mfma_f32_16x16x32_bf16 v[64:67], a[96:99], a[16:19], v[44:47]
    s_xor_b32 s67, s46, 65536
    ds_read_b64_tr_b16 a[174:175], v23 offset:20480
    v_cvt_pk_bf16_f32 v88, v56, v57
    v_mfma_f32_16x16x32_bf16 v[64:67], a[100:103], a[20:23], v[64:67]
    v_exp_f32 v59, v59
    v_mfma_f32_16x16x32_bf16 v[64:67], a[104:107], a[24:27], v[64:67]
    buffer_load_dwordx4 v36, s[20:23], s67 offen offset:0 lds
    v_mfma_f32_16x16x32_bf16 v[64:67], a[108:111], a[28:31], v[64:67]
    v_exp_f32 v60, v60
    v_mfma_f32_16x16x32_bf16 v[68:71], a[112:115], a[16:19], v[44:47]
    ds_read_b64_tr_b16 a[176:177], v24 offset:16384
    v_cvt_pk_bf16_f32 v89, v58, v59
    v_mfma_f32_16x16x32_bf16 v[68:71], a[116:119], a[20:23], v[68:71]
    v_exp_f32 v61, v61
    v_mfma_f32_16x16x32_bf16 v[68:71], a[120:123], a[24:27], v[68:71]
    ds_read_b64_tr_b16 a[178:179], v24 offset:20480
    buffer_load_dwordx4 v37, s[20:23], s67 offen offset:1024 lds
    v_mfma_f32_16x16x32_bf16 v[68:71], a[124:127], a[28:31], v[68:71]
    v_exp_f32 v62, v62
    v_mfma_f32_16x16x32_bf16 v[140:143], a[192:195], v[100:103], v[140:143]
    ds_read_b64_tr_b16 a[180:181], v25 offset:16384
    v_cvt_pk_bf16_f32 v90, v60, v61
    v_mfma_f32_16x16x32_bf16 v[156:159], a[196:199], v[100:103], v[156:159]
    v_exp_f32 v63, v63
    v_mfma_f32_16x16x32_bf16 v[172:175], a[200:203], v[100:103], v[172:175]
    buffer_load_dwordx4 v38, s[20:23], s67 offen offset:2048 lds
    v_mfma_f32_16x16x32_bf16 v[188:191], a[204:207], v[100:103], v[188:191]
    ds_read_b64_tr_b16 a[182:183], v25 offset:20480
    v_cvt_pk_bf16_f32 v91, v62, v63
    v_mfma_f32_16x16x32_bf16 v[204:207], a[208:211], v[100:103], v[204:207]
    v_exp_f32 v64, v64
    v_mfma_f32_16x16x32_bf16 v[220:223], a[212:215], v[100:103], v[220:223]
    ds_read_b64_tr_b16 a[184:185], v26 offset:16384
    buffer_load_dwordx4 v39, s[20:23], s67 offen offset:3072 lds
    v_mfma_f32_16x16x32_bf16 v[236:239], a[216:219], v[100:103], v[236:239]
    v_exp_f32 v65, v65
    v_mfma_f32_16x16x32_bf16 v[252:255], a[220:223], v[100:103], v[252:255]
    s_add_u32 m0, s33, 32768
    ds_read_b64_tr_b16 a[186:187], v26 offset:20480
    v_mfma_f32_16x16x32_bf16 v[116:119], v[120:123], v[100:103], v[116:119]
    s_xor_b32 s67, s46, 131072
    v_exp_f32 v66, v66
    v_mfma_f32_16x16x32_bf16 v[72:75], a[96:99], a[32:35], v[48:51]
    ds_read_b64_tr_b16 a[188:189], v27 offset:16384
    v_cvt_pk_bf16_f32 v92, v64, v65
    v_mfma_f32_16x16x32_bf16 v[72:75], a[100:103], a[36:39], v[72:75]
    v_exp_f32 v67, v67
    v_mfma_f32_16x16x32_bf16 v[72:75], a[104:107], a[40:43], v[72:75]
    buffer_load_dwordx4 v36, s[20:23], s67 offen offset:0 lds
    v_mfma_f32_16x16x32_bf16 v[72:75], a[108:111], a[44:47], v[72:75]
    v_exp_f32 v68, v68
    v_mfma_f32_16x16x32_bf16 v[76:79], a[112:115], a[32:35], v[48:51]
    ds_read_b64_tr_b16 a[190:191], v27 offset:20480
    v_cvt_pk_bf16_f32 v93, v66, v67
    v_mfma_f32_16x16x32_bf16 v[76:79], a[116:119], a[36:39], v[76:79]
    v_exp_f32 v69, v69
    v_mfma_f32_16x16x32_bf16 v[76:79], a[120:123], a[40:43], v[76:79]
    ds_read_b128 a[64:67], v16 offset:32768
    buffer_load_dwordx4 v37, s[20:23], s67 offen offset:1024 lds
    v_mfma_f32_16x16x32_bf16 v[76:79], a[124:127], a[44:47], v[76:79]
    s_waitcnt lgkmcnt(3)
    buffer_load_dwordx4 v38, s[20:23], s67 offen offset:2048 lds
    v_exp_f32 v70, v70
    v_mfma_f32_16x16x32_bf16 v[128:131], a[160:163], v[88:91], v[128:131]
    ds_read_b128 a[68:71], v17 offset:32768
    v_cvt_pk_bf16_f32 v94, v68, v69
    v_mfma_f32_16x16x32_bf16 v[144:147], a[164:167], v[88:91], v[144:147]
    v_exp_f32 v71, v71
    v_mfma_f32_16x16x32_bf16 v[160:163], a[168:171], v[88:91], v[160:163]
    buffer_load_dwordx4 v39, s[20:23], s67 offen offset:3072 lds
    v_mfma_f32_16x16x32_bf16 v[176:179], a[172:175], v[88:91], v[176:179]
    ds_read_b128 a[72:75], v18 offset:32768
    v_cvt_pk_bf16_f32 v95, v70, v71
    v_mfma_f32_16x16x32_bf16 v[192:195], a[176:179], v[88:91], v[192:195]
    v_exp_f32 v72, v72
    v_mfma_f32_16x16x32_bf16 v[208:211], a[180:183], v[88:91], v[208:211]
    ds_read_b128 a[76:79], v19 offset:32768
    v_mfma_f32_16x16x32_bf16 v[224:227], a[184:187], v[88:91], v[224:227]
    s_waitcnt lgkmcnt(3)
    s_add_u32 m0, s33, 49152
    v_exp_f32 v73, v73
    v_mfma_f32_16x16x32_bf16 v[240:243], a[188:191], v[88:91], v[240:243]
    s_xor_b32 s67, s46, 196608
    ds_read_b128 a[80:83], v16 offset:36864
    v_mfma_f32_16x16x32_bf16 v[104:107], v[120:123], v[88:91], v[104:107]
    buffer_load_dwordx4 v36, s[20:23], s67 offen offset:0 lds
    v_exp_f32 v74, v74
    v_mfma_f32_16x16x32_bf16 v[80:83], a[96:99], a[48:51], v[52:55]
    ds_read_b128 a[84:87], v17 offset:36864
    v_cvt_pk_bf16_f32 v96, v72, v73
    v_mfma_f32_16x16x32_bf16 v[80:83], a[100:103], a[52:55], v[80:83]
    v_exp_f32 v75, v75
    v_mfma_f32_16x16x32_bf16 v[80:83], a[104:107], a[56:59], v[80:83]
    buffer_load_dwordx4 v37, s[20:23], s67 offen offset:1024 lds
    v_mfma_f32_16x16x32_bf16 v[80:83], a[108:111], a[60:63], v[80:83]
    v_exp_f32 v76, v76
    v_mfma_f32_16x16x32_bf16 v[84:87], a[112:115], a[48:51], v[52:55]
    ds_read_b128 a[88:91], v18 offset:36864
    v_cvt_pk_bf16_f32 v97, v74, v75
    v_mfma_f32_16x16x32_bf16 v[84:87], a[116:119], a[52:55], v[84:87]
    v_exp_f32 v77, v77
    v_mfma_f32_16x16x32_bf16 v[84:87], a[120:123], a[56:59], v[84:87]
    ds_read_b128 a[92:95], v19 offset:36864
    buffer_load_dwordx4 v38, s[20:23], s67 offen offset:2048 lds
    v_mfma_f32_16x16x32_bf16 v[84:87], a[124:127], a[60:63], v[84:87]
    v_exp_f32 v78, v78
    v_mfma_f32_16x16x32_bf16 v[132:135], a[160:163], v[92:95], v[132:135]
    v_cvt_pk_bf16_f32 v98, v76, v77
    v_mfma_f32_16x16x32_bf16 v[148:151], a[164:167], v[92:95], v[148:151]
    v_exp_f32 v79, v79
    v_mfma_f32_16x16x32_bf16 v[164:167], a[168:171], v[92:95], v[164:167]
    buffer_load_dwordx4 v39, s[20:23], s67 offen offset:3072 lds
    v_mfma_f32_16x16x32_bf16 v[180:183], a[172:175], v[92:95], v[180:183]
    v_cvt_pk_bf16_f32 v99, v78, v79
    v_mfma_f32_16x16x32_bf16 v[196:199], a[176:179], v[92:95], v[196:199]
    s_waitcnt vmcnt(20)
    v_exp_f32 v80, v80
    v_mfma_f32_16x16x32_bf16 v[212:215], a[180:183], v[92:95], v[212:215]
    s_waitcnt lgkmcnt(0)
    s_barrier
    v_mfma_f32_16x16x32_bf16 v[228:231], a[184:187], v[92:95], v[228:231]
    v_exp_f32 v81, v81
    v_mfma_f32_16x16x32_bf16 v[244:247], a[188:191], v[92:95], v[244:247]
    v_mfma_f32_16x16x32_bf16 v[108:111], v[120:123], v[92:95], v[108:111]
    v_exp_f32 v82, v82
    v_mfma_f32_16x16x32_bf16 v[56:59], a[64:67], a[0:3], v[40:43]
    s_add_u32 m0, s33, 65536
    ds_read_b64_tr_b16 a[128:129], v20 offset:32768
    v_cvt_pk_bf16_f32 v100, v80, v81
    v_mfma_f32_16x16x32_bf16 v[56:59], a[68:71], a[4:7], v[56:59]
    s_xor_b32 s67, s47, 0
    v_exp_f32 v83, v83
    v_mfma_f32_16x16x32_bf16 v[56:59], a[72:75], a[8:11], v[56:59]
    buffer_load_dwordx4 v36, s[20:23], s67 offen offset:0 lds
    v_mfma_f32_16x16x32_bf16 v[56:59], a[76:79], a[12:15], v[56:59]
    v_exp_f32 v84, v84
    v_mfma_f32_16x16x32_bf16 v[60:63], a[80:83], a[0:3], v[40:43]
    ds_read_b64_tr_b16 a[130:131], v20 offset:36864
    v_cvt_pk_bf16_f32 v101, v82, v83
    v_mfma_f32_16x16x32_bf16 v[60:63], a[84:87], a[4:7], v[60:63]
    v_exp_f32 v85, v85
    v_mfma_f32_16x16x32_bf16 v[60:63], a[88:91], a[8:11], v[60:63]
    s_waitcnt vmcnt(13)
    ds_read_b64_tr_b16 a[132:133], v21 offset:32768
    ds_read_b64_tr_b16 a[192:193], v28 offset:0
    v_mfma_f32_16x16x32_bf16 v[60:63], a[92:95], a[12:15], v[60:63]
    ds_read_b64_tr_b16 a[194:195], v28 offset:1024
    v_exp_f32 v86, v86
    v_mfma_f32_16x16x32_bf16 v[136:139], a[160:163], v[96:99], v[136:139]
    ds_read_b64_tr_b16 a[134:135], v21 offset:36864
    v_cvt_pk_bf16_f32 v102, v84, v85
    v_mfma_f32_16x16x32_bf16 v[152:155], a[164:167], v[96:99], v[152:155]
    v_exp_f32 v87, v87
    v_mfma_f32_16x16x32_bf16 v[168:171], a[168:171], v[96:99], v[168:171]
    buffer_load_dwordx4 v37, s[20:23], s67 offen offset:1024 lds
    ds_read_b64_tr_b16 a[196:197], v28 offset:2048
    v_mfma_f32_16x16x32_bf16 v[184:187], a[172:175], v[96:99], v[184:187]
    ds_read_b64_tr_b16 a[136:137], v22 offset:32768
    ds_read_b64_tr_b16 a[198:199], v28 offset:3072
    v_cvt_pk_bf16_f32 v103, v86, v87
    v_mfma_f32_16x16x32_bf16 v[200:203], a[176:179], v[96:99], v[200:203]
    v_exp_f32 v56, v56
    v_mfma_f32_16x16x32_bf16 v[216:219], a[180:183], v[96:99], v[216:219]
    ds_read_b64_tr_b16 a[138:139], v22 offset:36864
    buffer_load_dwordx4 v38, s[20:23], s67 offen offset:2048 lds
    ds_read_b64_tr_b16 a[200:201], v29 offset:0
    v_mfma_f32_16x16x32_bf16 v[232:235], a[184:187], v[96:99], v[232:235]
    v_exp_f32 v57, v57
    v_mfma_f32_16x16x32_bf16 v[248:251], a[188:191], v[96:99], v[248:251]
    ds_read_b64_tr_b16 a[140:141], v23 offset:32768
    ds_read_b64_tr_b16 a[202:203], v29 offset:1024
    v_mfma_f32_16x16x32_bf16 v[112:115], v[120:123], v[96:99], v[112:115]
    ds_read_b64_tr_b16 a[204:205], v29 offset:2048
    v_exp_f32 v58, v58
    v_mfma_f32_16x16x32_bf16 v[64:67], a[64:67], a[16:19], v[44:47]
    ds_read_b64_tr_b16 a[142:143], v23 offset:36864
    v_cvt_pk_bf16_f32 v88, v56, v57
    v_mfma_f32_16x16x32_bf16 v[64:67], a[68:71], a[20:23], v[64:67]
    v_exp_f32 v59, v59
    v_mfma_f32_16x16x32_bf16 v[64:67], a[72:75], a[24:27], v[64:67]
    buffer_load_dwordx4 v39, s[20:23], s67 offen offset:3072 lds
    ds_read_b64_tr_b16 a[206:207], v29 offset:3072
    v_mfma_f32_16x16x32_bf16 v[64:67], a[76:79], a[28:31], v[64:67]
    s_waitcnt vmcnt(12)
    ds_read_b64_tr_b16 a[208:209], v28 offset:16384
    v_exp_f32 v60, v60
    v_mfma_f32_16x16x32_bf16 v[68:71], a[80:83], a[16:19], v[44:47]
    ds_read_b64_tr_b16 a[144:145], v24 offset:32768
    ds_read_b64_tr_b16 a[210:211], v28 offset:17408
    v_cvt_pk_bf16_f32 v89, v58, v59
    v_mfma_f32_16x16x32_bf16 v[68:71], a[84:87], a[20:23], v[68:71]
    v_exp_f32 v61, v61
    v_mfma_f32_16x16x32_bf16 v[68:71], a[88:91], a[24:27], v[68:71]
    ds_read_b64_tr_b16 a[146:147], v24 offset:36864
    ds_read_b64_tr_b16 a[212:213], v28 offset:18432
    v_mfma_f32_16x16x32_bf16 v[68:71], a[92:95], a[28:31], v[68:71]
    v_exp_f32 v62, v62
    v_mfma_f32_16x16x32_bf16 v[140:143], a[160:163], v[100:103], v[140:143]
    ds_read_b64_tr_b16 a[148:149], v25 offset:32768
    ds_read_b64_tr_b16 a[214:215], v28 offset:19456
    v_cvt_pk_bf16_f32 v90, v60, v61
    v_mfma_f32_16x16x32_bf16 v[156:159], a[164:167], v[100:103], v[156:159]
    s_waitcnt lgkmcnt(7)
    s_add_u32 m0, s33, 0
    v_exp_f32 v63, v63
    v_mfma_f32_16x16x32_bf16 v[172:175], a[168:171], v[100:103], v[172:175]
    s_xor_b32 s67, s47, 65536
    ds_read_b64_tr_b16 a[216:217], v29 offset:16384
    v_mfma_f32_16x16x32_bf16 v[188:191], a[172:175], v[100:103], v[188:191]
    ds_read_b64_tr_b16 a[150:151], v25 offset:36864
    ds_read_b64_tr_b16 a[218:219], v29 offset:17408
    v_cvt_pk_bf16_f32 v91, v62, v63
    v_mfma_f32_16x16x32_bf16 v[204:207], a[176:179], v[100:103], v[204:207]
    buffer_load_dwordx4 v36, s[20:23], s67 offen offset:0 lds
    v_exp_f32 v64, v64
    v_mfma_f32_16x16x32_bf16 v[220:223], a[180:183], v[100:103], v[220:223]
    ds_read_b64_tr_b16 a[152:153], v26 offset:32768
    ds_read_b64_tr_b16 a[220:221], v29 offset:18432
    v_mfma_f32_16x16x32_bf16 v[236:239], a[184:187], v[100:103], v[236:239]
    v_exp_f32 v65, v65
    v_mfma_f32_16x16x32_bf16 v[252:255], a[188:191], v[100:103], v[252:255]
    ds_read_b64_tr_b16 a[154:155], v26 offset:36864
    ds_read_b64_tr_b16 a[222:223], v29 offset:19456
    buffer_load_dwordx4 v37, s[20:23], s67 offen offset:1024 lds
    v_mfma_f32_16x16x32_bf16 v[116:119], v[120:123], v[100:103], v[116:119]
    v_exp_f32 v66, v66
    v_mfma_f32_16x16x32_bf16 v[72:75], a[64:67], a[32:35], v[48:51]
    ds_read_b64_tr_b16 a[156:157], v27 offset:32768
    v_cvt_pk_bf16_f32 v92, v64, v65
    v_mfma_f32_16x16x32_bf16 v[72:75], a[68:71], a[36:39], v[72:75]
    v_exp_f32 v67, v67
    v_mfma_f32_16x16x32_bf16 v[72:75], a[72:75], a[40:43], v[72:75]
    buffer_load_dwordx4 v38, s[20:23], s67 offen offset:2048 lds
    v_mfma_f32_16x16x32_bf16 v[72:75], a[76:79], a[44:47], v[72:75]
    v_exp_f32 v68, v68
    v_mfma_f32_16x16x32_bf16 v[76:79], a[80:83], a[32:35], v[48:51]
    ds_read_b64_tr_b16 a[158:159], v27 offset:36864
    v_cvt_pk_bf16_f32 v93, v66, v67
    v_mfma_f32_16x16x32_bf16 v[76:79], a[84:87], a[36:39], v[76:79]
    v_exp_f32 v69, v69
    v_mfma_f32_16x16x32_bf16 v[76:79], a[88:91], a[40:43], v[76:79]
    ds_read_b128 a[96:99], v16 offset:49152
    buffer_load_dwordx4 v39, s[20:23], s67 offen offset:3072 lds
    v_mfma_f32_16x16x32_bf16 v[76:79], a[92:95], a[44:47], v[76:79]
    v_exp_f32 v70, v70
    v_mfma_f32_16x16x32_bf16 v[128:131], a[128:131], v[88:91], v[128:131]
    ds_read_b128 a[100:103], v17 offset:49152
    v_cvt_pk_bf16_f32 v94, v68, v69
    v_mfma_f32_16x16x32_bf16 v[144:147], a[132:135], v[88:91], v[144:147]
    v_exp_f32 v71, v71
    v_mfma_f32_16x16x32_bf16 v[160:163], a[136:139], v[88:91], v[160:163]
    s_waitcnt vmcnt(12)
    s_waitcnt lgkmcnt(4)
    s_add_u32 m0, s33, 16384
    ds_read_b64_tr_b16 a[224:225], v28 offset:32768
    v_mfma_f32_16x16x32_bf16 v[176:179], a[140:143], v[88:91], v[176:179]
    s_xor_b32 s67, s47, 131072
    ds_read_b128 a[104:107], v18 offset:49152
    v_cvt_pk_bf16_f32 v95, v70, v71
    v_mfma_f32_16x16x32_bf16 v[192:195], a[144:147], v[88:91], v[192:195]
    buffer_load_dwordx4 v36, s[20:23], s67 offen offset:0 lds
    v_exp_f32 v72, v72
    v_mfma_f32_16x16x32_bf16 v[208:211], a[148:151], v[88:91], v[208:211]
    ds_read_b128 a[108:111], v19 offset:49152
    ds_read_b64_tr_b16 a[226:227], v28 offset:33792
    v_mfma_f32_16x16x32_bf16 v[224:227], a[152:155], v[88:91], v[224:227]
    s_waitcnt lgkmcnt(5)
    v_exp_f32 v73, v73
    v_mfma_f32_16x16x32_bf16 v[240:243], a[156:159], v[88:91], v[240:243]
    ds_read_b128 a[112:115], v16 offset:53248
    ds_read_b64_tr_b16 a[228:229], v28 offset:34816
    v_mfma_f32_16x16x32_bf16 v[104:107], v[120:123], v[88:91], v[104:107]
    ds_read_b64_tr_b16 a[230:231], v28 offset:35840
    v_exp_f32 v74, v74
    v_mfma_f32_16x16x32_bf16 v[80:83], a[64:67], a[48:51], v[52:55]
    ds_read_b128 a[116:119], v17 offset:53248
    v_cvt_pk_bf16_f32 v96, v72, v73
    v_mfma_f32_16x16x32_bf16 v[80:83], a[68:71], a[52:55], v[80:83]
    v_exp_f32 v75, v75
    v_mfma_f32_16x16x32_bf16 v[80:83], a[72:75], a[56:59], v[80:83]
    ds_read_b64_tr_b16 a[232:233], v29 offset:32768
    buffer_load_dwordx4 v37, s[20:23], s67 offen offset:1024 lds
    v_mfma_f32_16x16x32_bf16 v[80:83], a[76:79], a[60:63], v[80:83]
    ds_read_b64_tr_b16 a[234:235], v29 offset:33792
    v_exp_f32 v76, v76
    v_mfma_f32_16x16x32_bf16 v[84:87], a[80:83], a[48:51], v[52:55]
    ds_read_b128 a[120:123], v18 offset:53248
    buffer_load_dwordx4 v38, s[20:23], s67 offen offset:2048 lds
    v_cvt_pk_bf16_f32 v97, v74, v75
    v_mfma_f32_16x16x32_bf16 v[84:87], a[84:87], a[52:55], v[84:87]
    v_exp_f32 v77, v77
    v_mfma_f32_16x16x32_bf16 v[84:87], a[88:91], a[56:59], v[84:87]
    ds_read_b128 a[124:127], v19 offset:53248
    ds_read_b64_tr_b16 a[236:237], v29 offset:34816
    v_mfma_f32_16x16x32_bf16 v[84:87], a[92:95], a[60:63], v[84:87]
    v_exp_f32 v78, v78
    v_mfma_f32_16x16x32_bf16 v[132:135], a[128:131], v[92:95], v[132:135]
    ds_read_b64_tr_b16 a[238:239], v29 offset:35840
    v_cvt_pk_bf16_f32 v98, v76, v77
    v_mfma_f32_16x16x32_bf16 v[148:151], a[132:135], v[92:95], v[148:151]
    v_exp_f32 v79, v79
    v_mfma_f32_16x16x32_bf16 v[164:167], a[136:139], v[92:95], v[164:167]
    buffer_load_dwordx4 v39, s[20:23], s67 offen offset:3072 lds
    v_mfma_f32_16x16x32_bf16 v[180:183], a[140:143], v[92:95], v[180:183]
    v_cvt_pk_bf16_f32 v99, v78, v79
    v_mfma_f32_16x16x32_bf16 v[196:199], a[144:147], v[92:95], v[196:199]
    v_exp_f32 v80, v80
    v_mfma_f32_16x16x32_bf16 v[212:215], a[148:151], v[92:95], v[212:215]
    s_waitcnt lgkmcnt(0)
    s_barrier
    v_mfma_f32_16x16x32_bf16 v[228:231], a[152:155], v[92:95], v[228:231]
    v_exp_f32 v81, v81
    v_mfma_f32_16x16x32_bf16 v[244:247], a[156:159], v[92:95], v[244:247]
    s_waitcnt vmcnt(12)
    s_add_u32 m0, s33, 32768
    buffer_load_dword v35, v15, s[52:55], s40 offen sc1
    ds_read_b64_tr_b16 a[240:241], v28 offset:49152
    v_mfma_f32_16x16x32_bf16 v[108:111], v[120:123], v[92:95], v[108:111]
    s_xor_b32 s67, s47, 196608
    ds_read_b64_tr_b16 a[242:243], v28 offset:50176
    v_exp_f32 v82, v82
    v_mfma_f32_16x16x32_bf16 v[56:59], a[96:99], a[0:3], v[40:43]
    ds_read_b64_tr_b16 a[160:161], v20 offset:49152
    v_cvt_pk_bf16_f32 v100, v80, v81
    v_mfma_f32_16x16x32_bf16 v[56:59], a[100:103], a[4:7], v[56:59]
    v_exp_f32 v83, v83
    v_mfma_f32_16x16x32_bf16 v[56:59], a[104:107], a[8:11], v[56:59]
    ds_read_b64_tr_b16 a[244:245], v28 offset:51200
    buffer_load_dwordx4 v36, s[20:23], s67 offen offset:0 lds
    v_mfma_f32_16x16x32_bf16 v[56:59], a[108:111], a[12:15], v[56:59]
    ds_read_b64_tr_b16 a[246:247], v28 offset:52224
    v_exp_f32 v84, v84
    v_mfma_f32_16x16x32_bf16 v[60:63], a[112:115], a[0:3], v[40:43]
    ds_read_b64_tr_b16 a[162:163], v20 offset:53248
    buffer_load_dwordx4 v37, s[20:23], s67 offen offset:1024 lds
    v_cvt_pk_bf16_f32 v101, v82, v83
    v_mfma_f32_16x16x32_bf16 v[60:63], a[116:119], a[4:7], v[60:63]
    ds_read_b64_tr_b16 a[248:249], v29 offset:49152
    v_exp_f32 v85, v85
    v_mfma_f32_16x16x32_bf16 v[60:63], a[120:123], a[8:11], v[60:63]
    ds_read_b64_tr_b16 a[164:165], v21 offset:49152
    ds_read_b64_tr_b16 a[250:251], v29 offset:50176
    v_mfma_f32_16x16x32_bf16 v[60:63], a[124:127], a[12:15], v[60:63]
    buffer_load_dwordx4 v38, s[20:23], s67 offen offset:2048 lds
    v_exp_f32 v86, v86
    v_mfma_f32_16x16x32_bf16 v[136:139], a[128:131], v[96:99], v[136:139]
    ds_read_b64_tr_b16 a[166:167], v21 offset:53248
    v_cvt_pk_bf16_f32 v102, v84, v85
    v_lshrrev_b32 v40, 2, v4
    v_mfma_f32_16x16x32_bf16 v[152:155], a[132:135], v[96:99], v[152:155]
    ds_read_b64_tr_b16 a[252:253], v29 offset:51200
    v_exp_f32 v87, v87
    v_mfma_f32_16x16x32_bf16 v[168:171], a[136:139], v[96:99], v[168:171]
    ds_read_b64_tr_b16 a[254:255], v29 offset:52224
    v_cmp_eq_u32 vcc, v40, v3
    v_mfma_f32_16x16x32_bf16 v[184:187], a[140:143], v[96:99], v[184:187]
    ds_read_b64_tr_b16 a[168:169], v22 offset:49152
    v_cvt_pk_bf16_f32 v103, v86, v87
    v_mfma_f32_16x16x32_bf16 v[200:203], a[144:147], v[96:99], v[200:203]
    v_exp_f32 v56, v56
    v_and_b32 v40, 1, v2
    v_mfma_f32_16x16x32_bf16 v[216:219], a[148:151], v[96:99], v[216:219]
    ds_read_b64_tr_b16 a[170:171], v22 offset:53248
    buffer_load_dwordx4 v39, s[20:23], s67 offen offset:3072 lds
    v_mfma_f32_16x16x32_bf16 v[232:235], a[152:155], v[96:99], v[232:235]
    s_add_u32 m0, s33, 131072
    s_waitcnt vmcnt(13)
    ds_read_b64_tr_b16 a[64:65], v30 offset:0
    v_exp_f32 v57, v57
    v_lshlrev_b32 v40, 4, v40
    v_mfma_f32_16x16x32_bf16 v[248:251], a[156:159], v[96:99], v[248:251]
    s_xor_b32 s67, s48, 0
    ds_read_b64_tr_b16 a[172:173], v23 offset:49152
    ds_read_b64_tr_b16 a[66:67], v30 offset:1024
    v_mfma_f32_16x16x32_bf16 v[112:115], v[120:123], v[96:99], v[112:115]
    v_exp_f32 v58, v58
    v_mov_b32 v41, 0x3f80
    v_mfma_f32_16x16x32_bf16 v[64:67], a[96:99], a[16:19], v[44:47]
    ds_read_b64_tr_b16 a[174:175], v23 offset:53248
    buffer_load_dwordx4 v36, s[20:23], s67 offen offset:0 lds
    ds_read_b64_tr_b16 a[68:69], v30 offset:2048
    v_cvt_pk_bf16_f32 v88, v56, v57
    v_mfma_f32_16x16x32_bf16 v[64:67], a[100:103], a[20:23], v[64:67]
    v_exp_f32 v59, v59
    v_lshlrev_b32 v41, v40, v41
    v_mfma_f32_16x16x32_bf16 v[64:67], a[104:107], a[24:27], v[64:67]
    buffer_load_dwordx4 v37, s[20:23], s67 offen offset:1024 lds
    ds_read_b64_tr_b16 a[70:71], v30 offset:3072
    v_mfma_f32_16x16x32_bf16 v[64:67], a[108:111], a[28:31], v[64:67]
    v_exp_f32 v60, v60
    v_cndmask_b32 v41, 0, v41, vcc
    v_mfma_f32_16x16x32_bf16 v[68:71], a[112:115], a[16:19], v[44:47]
    ds_read_b64_tr_b16 a[176:177], v24 offset:49152
    ds_read_b64_tr_b16 a[72:73], v31 offset:0
    v_cvt_pk_bf16_f32 v89, v58, v59
    v_mfma_f32_16x16x32_bf16 v[68:71], a[116:119], a[20:23], v[68:71]
    v_exp_f32 v61, v61
    v_and_b32 v40, 2, v2
    v_mfma_f32_16x16x32_bf16 v[68:71], a[120:123], a[24:27], v[68:71]
    ds_read_b64_tr_b16 a[178:179], v24 offset:53248
    buffer_load_dwordx4 v38, s[20:23], s67 offen offset:2048 lds
    ds_read_b64_tr_b16 a[74:75], v31 offset:1024
    v_mfma_f32_16x16x32_bf16 v[68:71], a[124:127], a[28:31], v[68:71]
    v_exp_f32 v62, v62
    v_cmp_eq_u32 vcc, 0, v40
    v_mfma_f32_16x16x32_bf16 v[140:143], a[128:131], v[100:103], v[140:143]
    ds_read_b64_tr_b16 a[180:181], v25 offset:49152
    ds_read_b64_tr_b16 a[76:77], v31 offset:2048
    v_cvt_pk_bf16_f32 v90, v60, v61
    v_mfma_f32_16x16x32_bf16 v[156:159], a[132:135], v[100:103], v[156:159]
    v_exp_f32 v63, v63
    v_mfma_f32_16x16x32_bf16 v[172:175], a[136:139], v[100:103], v[172:175]
    buffer_load_dwordx4 v39, s[20:23], s67 offen offset:3072 lds
    ds_read_b64_tr_b16 a[78:79], v31 offset:3072
    v_mfma_f32_16x16x32_bf16 v[188:191], a[140:143], v[100:103], v[188:191]
    ds_read_b64_tr_b16 a[182:183], v25 offset:53248
    v_cvt_pk_bf16_f32 v91, v62, v63
    v_mfma_f32_16x16x32_bf16 v[204:207], a[144:147], v[100:103], v[204:207]
    v_exp_f32 v64, v64
    v_mfma_f32_16x16x32_bf16 v[220:223], a[148:151], v[100:103], v[220:223]
    s_waitcnt lgkmcnt(15)
    s_add_u32 m0, s33, 49152
    s_waitcnt vmcnt(13)
    ds_read_b64_tr_b16 a[184:185], v26 offset:49152
    ds_read_b64_tr_b16 a[80:81], v28 offset:0
    v_mfma_f32_16x16x32_bf16 v[236:239], a[152:155], v[100:103], v[236:239]
    s_xor_b32 s67, s48, 65536
    ds_read_b64_tr_b16 a[82:83], v28 offset:1024
    v_exp_f32 v65, v65
    v_mfma_f32_16x16x32_bf16 v[252:255], a[156:159], v[100:103], v[252:255]
    ds_read_b64_tr_b16 a[186:187], v26 offset:53248
    buffer_load_dwordx4 v36, s[20:23], s67 offen offset:0 lds
    v_mfma_f32_16x16x32_bf16 v[116:119], v[120:123], v[100:103], v[116:119]
    ds_read_b64_tr_b16 a[84:85], v28 offset:2048
    v_exp_f32 v66, v66
    v_mfma_f32_16x16x32_bf16 v[72:75], a[96:99], a[32:35], v[48:51]
    ds_read_b64_tr_b16 a[188:189], v27 offset:49152
    v_cvt_pk_bf16_f32 v92, v64, v65
    v_mfma_f32_16x16x32_bf16 v[72:75], a[100:103], a[36:39], v[72:75]
    v_exp_f32 v67, v67
    v_mfma_f32_16x16x32_bf16 v[72:75], a[104:107], a[40:43], v[72:75]
    buffer_load_dwordx4 v37, s[20:23], s67 offen offset:1024 lds
    ds_read_b64_tr_b16 a[86:87], v28 offset:3072
    v_mfma_f32_16x16x32_bf16 v[72:75], a[108:111], a[44:47], v[72:75]
    ds_read_b64_tr_b16 a[88:89], v29 offset:0
    v_exp_f32 v68, v68
    v_mfma_f32_16x16x32_bf16 v[76:79], a[112:115], a[32:35], v[48:51]
    ds_read_b64_tr_b16 a[190:191], v27 offset:53248
    ds_read_b64_tr_b16 a[90:91], v29 offset:1024
    v_cvt_pk_bf16_f32 v93, v66, v67
    v_mfma_f32_16x16x32_bf16 v[76:79], a[116:119], a[36:39], v[76:79]
    v_exp_f32 v69, v69
    v_mfma_f32_16x16x32_bf16 v[76:79], a[120:123], a[40:43], v[76:79]
    buffer_load_dwordx4 v38, s[20:23], s67 offen offset:2048 lds
    ds_read_b64_tr_b16 a[92:93], v29 offset:2048
    v_mfma_f32_16x16x32_bf16 v[76:79], a[124:127], a[44:47], v[76:79]
    v_exp_f32 v70, v70
    v_mfma_f32_16x16x32_bf16 v[128:131], a[160:163], v[88:91], v[128:131]
    ds_read_b64_tr_b16 a[94:95], v29 offset:3072
    v_cvt_pk_bf16_f32 v94, v68, v69
    v_mov_b32 v46, 0
    v_mov_b32 v47, 0
    v_mfma_f32_16x16x32_bf16 v[144:147], a[164:167], v[88:91], v[144:147]
    s_waitcnt lgkmcnt(6)
    v_exp_f32 v71, v71
    v_cndmask_b32 v48, 0, v41, vcc
    v_cndmask_b32 v49, v41, 0, vcc
    v_mfma_f32_16x16x32_bf16 v[160:163], a[168:171], v[88:91], v[160:163]
    v_mov_b32 v50, 0
    v_mov_b32 v51, 0
    v_mfma_f32_16x16x32_bf16 v[176:179], a[172:175], v[88:91], v[176:179]
    buffer_load_dwordx4 v39, s[20:23], s67 offen offset:3072 lds
    v_cvt_pk_bf16_f32 v95, v70, v71
    v_mfma_f32_16x16x32_bf16 v[192:195], a[176:179], v[88:91], v[192:195]
    v_exp_f32 v72, v72
    v_mfma_f32_16x16x32_bf16 v[208:211], a[180:183], v[88:91], v[208:211]
    v_cvt_pk_bf16_f32 v56, v128, v129
    v_cvt_pk_bf16_f32 v57, v130, v131
    v_mfma_f32_16x16x32_bf16 v[224:227], a[184:187], v[88:91], v[224:227]
    s_waitcnt lgkmcnt(1)
    s_add_u32 m0, s33, 65536
    v_exp_f32 v73, v73
    v_cvt_pk_bf16_f32 v58, v144, v145
    v_mfma_f32_16x16x32_bf16 v[240:243], a[188:191], v[88:91], v[240:243]
    s_xor_b32 s67, s48, 131072
    v_cvt_pk_bf16_f32 v59, v146, v147
    v_mfma_f32_16x16x32_bf16 v[104:107], v[120:123], v[88:91], v[104:107]
    ds_write_b128 v124, v[56:59] offset:0
    v_exp_f32 v74, v74
    v_cvt_pk_bf16_f32 v60, v160, v161
    v_cvt_pk_bf16_f32 v61, v162, v163
    v_mfma_f32_16x16x32_bf16 v[80:83], a[96:99], a[48:51], v[52:55]
    buffer_load_dwordx4 v36, s[20:23], s67 offen offset:0 lds
    v_cvt_pk_bf16_f32 v96, v72, v73
    v_cvt_pk_bf16_f32 v62, v176, v177
    v_mfma_f32_16x16x32_bf16 v[80:83], a[100:103], a[52:55], v[80:83]
    v_exp_f32 v75, v75
    v_cvt_pk_bf16_f32 v63, v178, v179
    v_mfma_f32_16x16x32_bf16 v[80:83], a[104:107], a[56:59], v[80:83]
    ds_write_b128 v124, v[60:63] offset:1024
    v_cvt_pk_bf16_f32 v64, v192, v193
    v_cvt_pk_bf16_f32 v65, v194, v195
    v_mfma_f32_16x16x32_bf16 v[80:83], a[108:111], a[60:63], v[80:83]
    v_exp_f32 v76, v76
    v_cvt_pk_bf16_f32 v66, v208, v209
    v_mfma_f32_16x16x32_bf16 v[84:87], a[112:115], a[48:51], v[52:55]
    buffer_load_dwordx4 v37, s[20:23], s67 offen offset:1024 lds
    v_cvt_pk_bf16_f32 v97, v74, v75
    v_cvt_pk_bf16_f32 v67, v210, v211
    v_mfma_f32_16x16x32_bf16 v[84:87], a[116:119], a[52:55], v[84:87]
    ds_write_b128 v124, v[64:67] offset:2048
    v_exp_f32 v77, v77
    v_cvt_pk_bf16_f32 v68, v224, v225
    v_cvt_pk_bf16_f32 v69, v226, v227
    v_mfma_f32_16x16x32_bf16 v[84:87], a[120:123], a[56:59], v[84:87]
    ds_write_b32 v5, v104 offset:0
    v_cvt_pk_bf16_f32 v70, v240, v241
    v_mfma_f32_16x16x32_bf16 v[84:87], a[124:127], a[60:63], v[84:87]
    v_exp_f32 v78, v78
    v_cvt_pk_bf16_f32 v71, v242, v243
    v_mfma_f32_16x16x32_bf16 v[132:135], a[160:163], v[92:95], v[132:135]
    ds_write_b128 v124, v[68:71] offset:3072
    v_cvt_pk_bf16_f32 v98, v76, v77
    v_mfma_f32_16x16x32_bf16 v[148:151], a[164:167], v[92:95], v[148:151]
    v_exp_f32 v79, v79
    v_mfma_f32_16x16x32_bf16 v[164:167], a[168:171], v[92:95], v[164:167]
    buffer_load_dwordx4 v38, s[20:23], s67 offen offset:2048 lds
    v_mfma_f32_16x16x32_bf16 v[180:183], a[172:175], v[92:95], v[180:183]
    buffer_load_dwordx4 v39, s[20:23], s67 offen offset:3072 lds
    v_cvt_pk_bf16_f32 v99, v78, v79
    v_mfma_f32_16x16x32_bf16 v[196:199], a[176:179], v[92:95], v[196:199]
    v_exp_f32 v80, v80
    v_mfma_f32_16x16x32_bf16 v[212:215], a[180:183], v[92:95], v[212:215]
    s_waitcnt lgkmcnt(0)
    s_barrier
    ds_read_b32 v40, v6 offset:0
    ds_read_b128 v[128:131], v125 offset:0
    v_mfma_f32_16x16x32_bf16 v[228:231], a[184:187], v[92:95], v[228:231]
    ds_read_b128 v[160:163], v125 offset:1024
    ds_read_b128 v[192:195], v125 offset:2048
    v_exp_f32 v81, v81
    v_mfma_f32_16x16x32_bf16 v[244:247], a[188:191], v[92:95], v[244:247]
    ds_read_b128 v[224:227], v125 offset:3072
    v_mfma_f32_16x16x32_bf16 v[108:111], v[120:123], v[92:95], v[108:111]
    s_add_u32 m0, s33, 0
    v_exp_f32 v82, v82
    v_mfma_f32_16x16x32_bf16 v[136:139], a[160:163], v[96:99], v[136:139]
    s_xor_b32 s67, s48, 196608
    v_cvt_pk_bf16_f32 v100, v80, v81
    v_exp_f32 v83, v83
    v_mfma_f32_16x16x32_bf16 v[152:155], a[164:167], v[96:99], v[152:155]
    s_waitcnt vmcnt(17)
    ds_read_b64_tr_b16 a[96:97], v28 offset:16384
    v_exp_f32 v84, v84
    v_mfma_f32_16x16x32_bf16 v[168:171], a[168:171], v[96:99], v[168:171]
    buffer_load_dwordx4 v36, s[20:23], s67 offen offset:0 lds
    ds_read_b64_tr_b16 a[98:99], v28 offset:17408
    v_cvt_pk_bf16_f32 v101, v82, v83
    v_mfma_f32_16x16x32_bf16 v[184:187], a[172:175], v[96:99], v[184:187]
    s_waitcnt lgkmcnt(5)
    ds_read_b64_tr_b16 a[100:101], v28 offset:18432
    v_exp_f32 v85, v85
    v_add_f32 v40, v40, v108
    v_rcp_f32 v41, v40
    v_mfma_f32_16x16x32_bf16 v[132:135], v[48:51], v[128:131], v[132:135]
    ds_read_b64_tr_b16 a[102:103], v28 offset:19456
    v_exp_f32 v86, v86
    v_mfma_f32_16x16x32_bf16 v[148:151], v[46:49], v[128:131], v[148:151]
    s_waitcnt lgkmcnt(5)
    buffer_load_dwordx4 v37, s[20:23], s67 offen offset:1024 lds
    ds_read_b64_tr_b16 a[104:105], v29 offset:16384
    v_cvt_pk_bf16_f32 v102, v84, v85
    v_mfma_f32_16x16x32_bf16 v[164:167], v[48:51], v[160:163], v[164:167]
    ds_read_b64_tr_b16 a[106:107], v29 offset:17408
    v_exp_f32 v87, v87
    v_mfma_f32_16x16x32_bf16 v[180:183], v[46:49], v[160:163], v[180:183]
    buffer_load_dwordx4 v38, s[20:23], s67 offen offset:2048 lds
    ds_read_b64_tr_b16 a[108:109], v29 offset:18432
    v_cvt_pk_bf16_f32 v103, v86, v87
    v_mfma_f32_16x16x32_bf16 v[196:199], v[48:51], v[192:195], v[196:199]
    ds_read_b64_tr_b16 a[110:111], v29 offset:19456
    v_cvt_pk_bf16_f32 v72, v136, v137
    v_cvt_pk_bf16_f32 v73, v138, v139
    v_mfma_f32_16x16x32_bf16 v[212:215], v[46:49], v[192:195], v[212:215]
    s_waitcnt lgkmcnt(7)
    buffer_load_dwordx4 v39, s[20:23], s67 offen offset:3072 lds
    v_mul_f32 v132, v41, v132
    v_mul_f32 v133, v41, v133
    v_mul_f32 v134, v41, v134
    v_cvt_pk_bf16_f32 v74, v152, v153
    v_cvt_pk_bf16_f32 v75, v154, v155
    v_mfma_f32_16x16x32_bf16 v[228:231], v[48:51], v[224:227], v[228:231]
    ds_write_b128 v124, v[72:75] offset:16384
    v_mul_f32 v135, v41, v135
    v_mul_f32 v148, v41, v148
    v_mul_f32 v149, v41, v149
    v_cvt_pk_bf16_f32 v76, v168, v169
    v_cvt_pk_bf16_f32 v77, v170, v171
    v_mfma_f32_16x16x32_bf16 v[244:247], v[46:49], v[224:227], v[244:247]
    v_mul_f32 v150, v41, v150
    v_mul_f32 v151, v41, v151
    v_cvt_pk_bf16_f32 v56, v132, v133
    v_cvt_pk_bf16_f32 v78, v184, v185
    v_cvt_pk_bf16_f32 v79, v186, v187
    v_mfma_f32_16x16x32_bf16 v[200:203], a[176:179], v[96:99], v[200:203]
    s_add_u32 m0, s33, 147456
    ds_write_b128 v124, v[76:79] offset:17408
    v_cvt_pk_bf16_f32 v57, v134, v135
    v_cvt_pk_bf16_f32 v58, v148, v149
    v_cvt_pk_bf16_f32 v59, v150, v151
    v_mfma_f32_16x16x32_bf16 v[216:219], a[180:183], v[96:99], v[216:219]
    s_xor_b32 s67, s49, 0
    ds_write_b128 v125, v[56:59] offset:0
    v_mul_f32 v164, v41, v164
    v_mul_f32 v165, v41, v165
    v_mul_f32 v166, v41, v166
    v_mfma_f32_16x16x32_bf16 v[232:235], a[184:187], v[96:99], v[232:235]
    buffer_load_dwordx4 v36, s[20:23], s67 offen offset:0 lds
    v_mul_f32 v167, v41, v167
    v_mul_f32 v180, v41, v180
    v_mul_f32 v181, v41, v181
    v_mfma_f32_16x16x32_bf16 v[248:251], a[188:191], v[96:99], v[248:251]
    v_mul_f32 v182, v41, v182
    v_mul_f32 v183, v41, v183
    v_cvt_pk_bf16_f32 v60, v164, v165
    v_mfma_f32_16x16x32_bf16 v[112:115], v[120:123], v[96:99], v[112:115]
    buffer_load_dwordx4 v37, s[20:23], s67 offen offset:1024 lds
    v_cvt_pk_bf16_f32 v61, v166, v167
    v_cvt_pk_bf16_f32 v62, v180, v181
    v_cvt_pk_bf16_f32 v63, v182, v183
    v_mfma_f32_16x16x32_bf16 v[140:143], a[160:163], v[100:103], v[140:143]
    ds_write_b128 v125, v[60:63] offset:1024
    v_mul_f32 v196, v41, v196
    v_mul_f32 v197, v41, v197
    v_mul_f32 v198, v41, v198
    v_cvt_pk_bf16_f32 v80, v200, v201
    v_cvt_pk_bf16_f32 v81, v202, v203
    v_mfma_f32_16x16x32_bf16 v[156:159], a[164:167], v[100:103], v[156:159]
    v_mul_f32 v199, v41, v199
    v_mul_f32 v212, v41, v212
    v_mul_f32 v213, v41, v213
    v_cvt_pk_bf16_f32 v82, v216, v217
    v_cvt_pk_bf16_f32 v83, v218, v219
    v_mfma_f32_16x16x32_bf16 v[172:175], a[168:171], v[100:103], v[172:175]
    ds_write_b128 v124, v[80:83] offset:18432
    v_mul_f32 v214, v41, v214
    v_mul_f32 v215, v41, v215
    v_cvt_pk_bf16_f32 v64, v196, v197
    v_cvt_pk_bf16_f32 v84, v232, v233
    v_cvt_pk_bf16_f32 v85, v234, v235
    v_mfma_f32_16x16x32_bf16 v[188:191], a[172:175], v[100:103], v[188:191]
    buffer_load_dwordx4 v38, s[20:23], s67 offen offset:2048 lds
    v_cvt_pk_bf16_f32 v65, v198, v199
    v_cvt_pk_bf16_f32 v66, v212, v213
    v_cvt_pk_bf16_f32 v67, v214, v215
    v_cvt_pk_bf16_f32 v86, v248, v249
    v_cvt_pk_bf16_f32 v87, v250, v251
    v_mfma_f32_16x16x32_bf16 v[204:207], a[176:179], v[100:103], v[204:207]
    ds_write_b128 v125, v[64:67] offset:2048
    ds_write_b128 v124, v[84:87] offset:19456
    ds_write_b32 v5, v112 offset:1024
    v_mul_f32 v228, v41, v228
    v_mul_f32 v229, v41, v229
    v_mul_f32 v230, v41, v230
    v_mfma_f32_16x16x32_bf16 v[220:223], a[180:183], v[100:103], v[220:223]
    buffer_load_dwordx4 v39, s[20:23], s67 offen offset:3072 lds
    v_mul_f32 v231, v41, v231
    v_mul_f32 v244, v41, v244
    v_mul_f32 v245, v41, v245
    v_mfma_f32_16x16x32_bf16 v[236:239], a[184:187], v[100:103], v[236:239]
    s_waitcnt vmcnt(24)
    v_mul_f32 v246, v41, v246
    v_mul_f32 v247, v41, v247
    v_cvt_pk_bf16_f32 v68, v228, v229
    v_cmp_ne_u32 vcc, v34, v35
    v_mfma_f32_16x16x32_bf16 v[252:255], a[188:191], v[100:103], v[252:255]
    v_cvt_pk_bf16_f32 v69, v230, v231
    v_cvt_pk_bf16_f32 v70, v244, v245
    v_cvt_pk_bf16_f32 v71, v246, v247
    v_mfma_f32_16x16x32_bf16 v[116:119], v[120:123], v[100:103], v[116:119]
    ds_write_b128 v125, v[68:71] offset:3072
    s_waitcnt lgkmcnt(0)
    s_cbranch_vccnz L_cntwait
L_cntok:
    s_barrier
    ds_read_b128 a[128:131], v126 offset:4096
    ds_read_b128 a[132:135], v126 offset:5120
    ds_read_b128 a[136:139], v126 offset:6144
    ds_read_b128 a[140:143], v126 offset:7168
    ds_read_b128 v[136:139], v125 offset:16384
    ds_read_b128 v[168:171], v125 offset:17408
    ds_read_b128 v[200:203], v125 offset:18432
    ds_read_b128 v[232:235], v125 offset:19456
    ds_read_b32 v42, v6 offset:1024
    s_waitcnt lgkmcnt(8)
    v_mfma_f32_16x16x32_bf16 v[128:131], a[192:195], a[128:131], 0
    s_waitcnt lgkmcnt(7)
    ds_read_b128 a[144:147], v127 offset:4096
    v_lshl_add_u32 v35, v1, 14, v14
    v_mfma_f32_16x16x32_bf16 v[128:131], a[196:199], a[132:135], v[128:131]
    s_waitcnt lgkmcnt(7)
    ds_read_b128 a[148:151], v127 offset:5120
    v_mov_b32 v34, s35
    v_mfma_f32_16x16x32_bf16 v[128:131], a[208:211], a[136:139], v[128:131]
    s_waitcnt lgkmcnt(7)
    s_add_u32 m0, s33, 16384
    ds_read_b128 a[152:155], v127 offset:6144
    v_lshl_add_u32 v5, v34, 10, v35
    v_mfma_f32_16x16x32_bf16 v[128:131], a[212:215], a[140:143], v[128:131]
    s_waitcnt lgkmcnt(7)
    s_xor_b32 s67, s49, 65536
    ds_read_b128 a[156:159], v127 offset:7168
    v_mfma_f32_16x16x32_bf16 v[140:143], v[48:51], v[136:139], v[140:143]
    buffer_load_dwordx4 v36, s[20:23], s67 offen offset:0 lds
    v_mfma_f32_16x16x32_bf16 v[156:159], v[46:49], v[136:139], v[156:159]
    s_waitcnt lgkmcnt(7)
    s_waitcnt lgkmcnt(4)
    ds_read_b128 a[160:163], v126 offset:0
    v_add_f32 v42, v42, v116
    v_rcp_f32 v43, v42
    v_mfma_f32_16x16x32_bf16 v[172:175], v[48:51], v[168:171], v[172:175]
    ds_read_b128 a[164:167], v126 offset:1024
    v_add_f32 v44, v40, v42
    v_add_u32 v45, 83968, v14
    v_mfma_f32_16x16x32_bf16 v[188:191], v[46:49], v[168:171], v[188:191]
    ds_read_b128 a[168:171], v126 offset:2048
    ds_write_b32 v7, v44
    v_mfma_f32_16x16x32_bf16 v[204:207], v[48:51], v[200:203], v[204:207]
    ds_read_b128 a[172:175], v126 offset:3072
    buffer_load_dwordx4 v37, s[20:23], s67 offen offset:1024 lds
    v_mfma_f32_16x16x32_bf16 v[220:223], v[46:49], v[200:203], v[220:223]
    ds_read_b128 a[176:179], v127 offset:0
    v_mfma_f32_16x16x32_bf16 v[236:239], v[48:51], v[232:235], v[236:239]
    ds_read_b128 a[180:183], v127 offset:1024
    v_mul_f32 v140, v43, v140
    v_mul_f32 v141, v43, v141
    v_mul_f32 v142, v43, v142
    v_mfma_f32_16x16x32_bf16 v[252:255], v[46:49], v[232:235], v[252:255]
    s_waitcnt lgkmcnt(7)
    ds_read_b128 a[184:187], v127 offset:2048
    v_mul_f32 v143, v43, v143
    v_mul_f32 v156, v43, v156
    v_mfma_f32_16x16x32_bf16 v[128:131], a[224:227], a[144:147], v[128:131]
    ds_read_b128 a[188:191], v127 offset:3072
    v_mul_f32 v157, v43, v157
    v_mul_f32 v158, v43, v158
    v_mul_f32 v159, v43, v159
    v_mfma_f32_16x16x32_bf16 v[128:131], a[228:231], a[148:151], v[128:131]
    s_waitcnt vmcnt(22)
    ds_read_b64_tr_b16 a[112:113], v28 offset:32768
    buffer_load_dwordx4 v38, s[20:23], s67 offen offset:2048 lds
    v_cvt_pk_bf16_f32 v72, v140, v141
    v_cvt_pk_bf16_f32 v73, v142, v143
    v_mfma_f32_16x16x32_bf16 v[128:131], a[240:243], a[152:155], v[128:131]
    ds_read_b64_tr_b16 a[114:115], v28 offset:33792
    v_cvt_pk_bf16_f32 v74, v156, v157
    v_cvt_pk_bf16_f32 v75, v158, v159
    v_mfma_f32_16x16x32_bf16 v[128:131], a[244:247], a[156:159], v[128:131]
    ds_write_b128 v125, v[72:75] offset:16384
    ds_read_b64_tr_b16 a[116:117], v28 offset:34816
    v_mul_f32 v172, v43, v172
    v_mul_f32 v173, v43, v173
    v_mul_f32 v174, v43, v174
    v_mfma_f32_16x16x32_bf16 v[132:135], a[200:203], a[128:131], 0
    ds_read_b64_tr_b16 a[118:119], v28 offset:35840
    buffer_load_dwordx4 v39, s[20:23], s67 offen offset:3072 lds
    v_mul_f32 v175, v43, v175
    v_mul_f32 v188, v43, v188
    v_mfma_f32_16x16x32_bf16 v[132:135], a[204:207], a[132:135], v[132:135]
    v_mul_f32 v189, v43, v189
    v_mul_f32 v190, v43, v190
    v_mul_f32 v191, v43, v191
    v_mfma_f32_16x16x32_bf16 v[132:135], a[216:219], a[136:139], v[132:135]
    ds_read_b64_tr_b16 a[120:121], v29 offset:32768
    v_cvt_pk_bf16_f32 v76, v172, v173
    v_cvt_pk_bf16_f32 v77, v174, v175
    v_mfma_f32_16x16x32_bf16 v[132:135], a[220:223], a[140:143], v[132:135]
    ds_read_b64_tr_b16 a[122:123], v29 offset:33792
    v_cvt_pk_bf16_f32 v78, v188, v189
    v_cvt_pk_bf16_f32 v79, v190, v191
    v_mfma_f32_16x16x32_bf16 v[132:135], a[232:235], a[144:147], v[132:135]
    ds_write_b128 v125, v[76:79] offset:17408
    ds_read_b64_tr_b16 a[124:125], v29 offset:34816
    v_mul_f32 v204, v43, v204
    v_mul_f32 v205, v43, v205
    v_mul_f32 v206, v43, v206
    v_mfma_f32_16x16x32_bf16 v[132:135], a[236:239], a[148:151], v[132:135]
    ds_read_b64_tr_b16 a[126:127], v29 offset:35840
    v_mul_f32 v207, v43, v207
    v_mul_f32 v220, v43, v220
    v_mfma_f32_16x16x32_bf16 v[132:135], a[248:251], a[152:155], v[132:135]
    v_mul_f32 v221, v43, v221
    v_mul_f32 v222, v43, v222
    v_mul_f32 v223, v43, v223
    v_mfma_f32_16x16x32_bf16 v[132:135], a[252:255], a[156:159], v[132:135]
    s_waitcnt lgkmcnt(6)
    v_cvt_pk_bf16_f32 v80, v204, v205
    v_cvt_pk_bf16_f32 v81, v206, v207
    v_mfma_f32_16x16x32_bf16 v[144:147], a[192:195], a[160:163], 0
    v_cvt_pk_bf16_f32 v82, v220, v221
    v_cvt_pk_bf16_f32 v83, v222, v223
    v_mfma_f32_16x16x32_bf16 v[144:147], a[196:199], a[164:167], v[144:147]
    ds_write_b128 v125, v[80:83] offset:18432
    v_mul_f32 v236, v43, v236
    v_mul_f32 v237, v43, v237
    v_mul_f32 v238, v43, v238
    v_mfma_f32_16x16x32_bf16 v[144:147], a[208:211], a[168:171], v[144:147]
    v_mul_f32 v239, v43, v239
    v_mul_f32 v252, v43, v252
    v_mfma_f32_16x16x32_bf16 v[144:147], a[212:215], a[172:175], v[144:147]
    v_mul_f32 v253, v43, v253
    v_mul_f32 v254, v43, v254
    v_mul_f32 v255, v43, v255
    v_mfma_f32_16x16x32_bf16 v[144:147], a[224:227], a[176:179], v[144:147]
    v_cvt_pk_bf16_f32 v84, v236, v237
    v_cvt_pk_bf16_f32 v85, v238, v239
    v_cvt_pk_bf16_f32 v56, v128, v129
    v_cvt_pk_bf16_f32 v57, v130, v131
    v_mfma_f32_16x16x32_bf16 v[144:147], a[228:231], a[180:183], v[144:147]
    s_add_u32 s63, s16, 0
    v_cvt_pk_bf16_f32 v86, v252, v253
    v_cvt_pk_bf16_f32 v87, v254, v255
    v_cvt_pk_bf16_f32 v58, v132, v133
    v_cvt_pk_bf16_f32 v59, v134, v135
    v_mfma_f32_16x16x32_bf16 v[144:147], a[240:243], a[184:187], v[144:147]
    s_cmp_eq_u32 s64, 0
    s_cselect_b32 s26, 0, 0x100000
    s_cselect_b64 s[42:43], -1, 0
    ds_write_b128 v125, v[84:87] offset:19456
    v_mfma_f32_16x16x32_bf16 v[144:147], a[244:247], a[188:191], v[144:147]
    buffer_store_dwordx4 v[56:59], v5, s[24:27], s63 offen sc1
    v_mfma_f32_16x16x32_bf16 v[148:151], a[200:203], a[160:163], 0
    v_cndmask_b32 v88, v88, v56, s[42:43]
    v_cndmask_b32 v89, v89, v57, s[42:43]
    v_mfma_f32_16x16x32_bf16 v[148:151], a[204:207], a[164:167], v[148:151]
    s_waitcnt lgkmcnt(0)
    s_barrier
    ds_read_b128 v[52:55], v45
    ds_read_b128 v[192:195], v126 offset:20480
    v_cndmask_b32 v90, v90, v58, s[42:43]
    v_cndmask_b32 v91, v91, v59, s[42:43]
    v_mfma_f32_16x16x32_bf16 v[148:151], a[216:219], a[168:171], v[148:151]
    s_add_u32 m0, s33, 32768
    ds_read_b128 v[196:199], v126 offset:21504
    ds_read_b128 v[200:203], v126 offset:22528
    v_mfma_f32_16x16x32_bf16 v[148:151], a[220:223], a[172:175], v[148:151]
    s_xor_b32 s67, s49, 131072
    ds_read_b128 v[204:207], v126 offset:23552
    ds_read_b128 v[208:211], v127 offset:20480
    v_mfma_f32_16x16x32_bf16 v[148:151], a[232:235], a[176:179], v[148:151]
    ds_read_b128 v[212:215], v127 offset:21504
    ds_read_b128 v[216:219], v127 offset:22528
    v_mfma_f32_16x16x32_bf16 v[148:151], a[236:239], a[180:183], v[148:151]
    s_mov_b32 s65, 0x53800000
    ds_read_b128 v[220:223], v127 offset:23552
    buffer_load_dwordx4 v36, s[20:23], s67 offen offset:0 lds
    v_mfma_f32_16x16x32_bf16 v[148:151], a[248:251], a[184:187], v[148:151]
    s_waitcnt lgkmcnt(8)
    v_add_f32 v52, v52, v53
    v_add_f32 v54, v54, v55
    v_mfma_f32_16x16x32_bf16 v[148:151], a[252:255], a[188:191], v[148:151]
    s_waitcnt lgkmcnt(7)
    v_add_f32 v52, v52, v54
    v_cmp_nge_f32 vcc, s65, v52
    v_mfma_f32_16x16x32_bf16 v[160:163], a[192:195], v[192:195], 0
    s_waitcnt lgkmcnt(6)
    ds_read_b128 v[224:227], v126 offset:16384
    buffer_load_dwordx4 v37, s[20:23], s67 offen offset:1024 lds
    v_mfma_f32_16x16x32_bf16 v[160:163], a[196:199], v[196:199], v[160:163]
    s_waitcnt lgkmcnt(6)
    s_cbranch_vccnz L_redo
L_noredo:
    ds_read_b128 v[228:231], v126 offset:17408
    v_mfma_f32_16x16x32_bf16 v[160:163], a[208:211], v[200:203], v[160:163]
    s_waitcnt lgkmcnt(6)
    s_waitcnt vmcnt(23)
    ds_read_b128 v[232:235], v126 offset:18432
    ds_read_b64_tr_b16 a[0:1], v32 offset:0
    v_mfma_f32_16x16x32_bf16 v[160:163], a[212:215], v[204:207], v[160:163]
    s_waitcnt lgkmcnt(7)
    ds_read_b128 v[236:239], v126 offset:19456
    buffer_load_dwordx4 v38, s[20:23], s67 offen offset:2048 lds
    ds_read_b64_tr_b16 a[2:3], v32 offset:1024
    v_mfma_f32_16x16x32_bf16 v[160:163], a[224:227], v[208:211], v[160:163]
    s_waitcnt lgkmcnt(7)
    ds_read_b128 v[240:243], v127 offset:16384
    ds_read_b64_tr_b16 a[4:5], v32 offset:2048
    v_cvt_pk_bf16_f32 v60, v144, v145
    v_cvt_pk_bf16_f32 v61, v146, v147
    v_mfma_f32_16x16x32_bf16 v[160:163], a[228:231], v[212:215], v[160:163]
    s_add_u32 s63, s16, 65536
    ds_read_b128 v[244:247], v127 offset:17408
    ds_read_b64_tr_b16 a[6:7], v32 offset:3072
    v_cvt_pk_bf16_f32 v62, v148, v149
    v_cvt_pk_bf16_f32 v63, v150, v151
    v_mfma_f32_16x16x32_bf16 v[160:163], a[240:243], v[216:219], v[160:163]
    s_waitcnt lgkmcnt(10)
    s_cmp_eq_u32 s64, 1
    s_cselect_b32 s26, 0, 0x100000
    s_cselect_b64 s[42:43], -1, 0
    ds_read_b128 v[248:251], v127 offset:18432
    v_mfma_f32_16x16x32_bf16 v[160:163], a[244:247], v[220:223], v[160:163]
    ds_read_b128 v[252:255], v127 offset:19456
    ds_read_b64_tr_b16 a[8:9], v33 offset:0
    buffer_store_dwordx4 v[60:63], v5, s[24:27], s63 offen sc1
    v_mfma_f32_16x16x32_bf16 v[164:167], a[200:203], v[192:195], 0
    buffer_load_dwordx4 v39, s[20:23], s67 offen offset:3072 lds
    ds_read_b64_tr_b16 a[10:11], v33 offset:1024
    v_cndmask_b32 v88, v88, v60, s[42:43]
    v_cndmask_b32 v89, v89, v61, s[42:43]
    v_mfma_f32_16x16x32_bf16 v[164:167], a[204:207], v[196:199], v[164:167]
    ds_read_b64_tr_b16 a[12:13], v33 offset:2048
    v_cndmask_b32 v90, v90, v62, s[42:43]
    v_cndmask_b32 v91, v91, v63, s[42:43]
    v_mfma_f32_16x16x32_bf16 v[164:167], a[216:219], v[200:203], v[164:167]
    ds_read_b64_tr_b16 a[14:15], v33 offset:3072
    v_mfma_f32_16x16x32_bf16 v[164:167], a[220:223], v[204:207], v[164:167]
    v_mfma_f32_16x16x32_bf16 v[164:167], a[232:235], v[208:211], v[164:167]
    v_mfma_f32_16x16x32_bf16 v[164:167], a[236:239], v[212:215], v[164:167]
    v_mfma_f32_16x16x32_bf16 v[164:167], a[248:251], v[216:219], v[164:167]
    v_mfma_f32_16x16x32_bf16 v[164:167], a[252:255], v[220:223], v[164:167]
    s_waitcnt lgkmcnt(3)
    v_mfma_f32_16x16x32_bf16 v[176:179], a[192:195], v[224:227], 0
    v_mfma_f32_16x16x32_bf16 v[176:179], a[196:199], v[228:231], v[176:179]
    s_waitcnt lgkmcnt(0)
    s_add_u32 m0, s33, 131072
    v_mfma_f32_16x16x32_bf16 v[176:179], a[208:211], v[232:235], v[176:179]
    s_xor_b32 s67, s49, 196608
    v_mfma_f32_16x16x32_bf16 v[176:179], a[212:215], v[236:239], v[176:179]
    buffer_load_dwordx4 v36, s[20:23], s67 offen offset:0 lds
    v_mfma_f32_16x16x32_bf16 v[176:179], a[224:227], v[240:243], v[176:179]
    v_cvt_pk_bf16_f32 v64, v160, v161
    v_cvt_pk_bf16_f32 v65, v162, v163
    v_mfma_f32_16x16x32_bf16 v[176:179], a[228:231], v[244:247], v[176:179]
    s_add_u32 s63, s16, 131072
    v_cvt_pk_bf16_f32 v66, v164, v165
    v_cvt_pk_bf16_f32 v67, v166, v167
    v_mfma_f32_16x16x32_bf16 v[176:179], a[240:243], v[248:251], v[176:179]
    s_cmp_eq_u32 s64, 2
    s_cselect_b32 s26, 0, 0x100000
    s_cselect_b64 s[42:43], -1, 0
    buffer_load_dwordx4 v37, s[20:23], s67 offen offset:1024 lds
    v_mfma_f32_16x16x32_bf16 v[176:179], a[244:247], v[252:255], v[176:179]
    buffer_store_dwordx4 v[64:67], v5, s[24:27], s63 offen sc1
    v_mfma_f32_16x16x32_bf16 v[180:183], a[200:203], v[224:227], 0
    v_cndmask_b32 v88, v88, v64, s[42:43]
    v_cndmask_b32 v89, v89, v65, s[42:43]
    v_mfma_f32_16x16x32_bf16 v[180:183], a[204:207], v[228:231], v[180:183]
    v_cndmask_b32 v90, v90, v66, s[42:43]
    v_cndmask_b32 v91, v91, v67, s[42:43]
    v_mfma_f32_16x16x32_bf16 v[180:183], a[216:219], v[232:235], v[180:183]
    buffer_load_dwordx4 v38, s[20:23], s67 offen offset:2048 lds
    v_mfma_f32_16x16x32_bf16 v[180:183], a[220:223], v[236:239], v[180:183]
    v_mfma_f32_16x16x32_bf16 v[180:183], a[232:235], v[240:243], v[180:183]
    v_mfma_f32_16x16x32_bf16 v[180:183], a[236:239], v[244:247], v[180:183]
    buffer_load_dwordx4 v39, s[20:23], s67 offen offset:3072 lds
    v_mfma_f32_16x16x32_bf16 v[180:183], a[248:251], v[248:251], v[180:183]
    v_mfma_f32_16x16x32_bf16 v[180:183], a[252:255], v[252:255], v[180:183]
    v_mfma_f32_16x16x32_bf16 v[136:139], a[64:67], a[128:131], 0
    v_mfma_f32_16x16x32_bf16 v[136:139], a[68:71], a[132:135], v[136:139]
    s_waitcnt vmcnt(27)
    ds_read_b64_tr_b16 a[16:17], v28 offset:49152
    v_mfma_f32_16x16x32_bf16 v[136:139], a[80:83], a[136:139], v[136:139]
    ds_read_b64_tr_b16 a[18:19], v28 offset:50176
    v_mfma_f32_16x16x32_bf16 v[136:139], a[84:87], a[140:143], v[136:139]
    ds_read_b64_tr_b16 a[20:21], v28 offset:51200
    v_mfma_f32_16x16x32_bf16 v[136:139], a[96:99], a[144:147], v[136:139]
    ds_read_b64_tr_b16 a[22:23], v28 offset:52224
    v_cvt_pk_bf16_f32 v68, v176, v177
    v_cvt_pk_bf16_f32 v69, v178, v179
    v_mfma_f32_16x16x32_bf16 v[136:139], a[100:103], a[148:151], v[136:139]
    s_add_u32 s63, s16, 196608
    v_cvt_pk_bf16_f32 v70, v180, v181
    v_cvt_pk_bf16_f32 v71, v182, v183
    v_mfma_f32_16x16x32_bf16 v[136:139], a[112:115], a[152:155], v[136:139]
    s_cmp_eq_u32 s64, 3
    s_cselect_b32 s26, 0, 0x100000
    s_cselect_b64 s[42:43], -1, 0
    ds_read_b64_tr_b16 a[24:25], v29 offset:49152
    v_mfma_f32_16x16x32_bf16 v[136:139], a[116:119], a[156:159], v[136:139]
    ds_read_b64_tr_b16 a[26:27], v29 offset:50176
    buffer_store_dwordx4 v[68:71], v5, s[24:27], s63 offen sc1
    v_mfma_f32_16x16x32_bf16 v[140:143], a[72:75], a[128:131], 0
    s_mov_b32 s26, 0x100000
    ds_read_b64_tr_b16 a[28:29], v29 offset:51200
    v_cndmask_b32 v88, v88, v68, s[42:43]
    v_cndmask_b32 v89, v89, v69, s[42:43]
    v_mfma_f32_16x16x32_bf16 v[140:143], a[76:79], a[132:135], v[140:143]
    ds_read_b64_tr_b16 a[30:31], v29 offset:52224
    v_cndmask_b32 v90, v90, v70, s[42:43]
    v_cndmask_b32 v91, v91, v71, s[42:43]
    v_mfma_f32_16x16x32_bf16 v[140:143], a[88:91], a[136:139], v[140:143]
    v_mfma_f32_16x16x32_bf16 v[140:143], a[92:95], a[140:143], v[140:143]
    v_mfma_f32_16x16x32_bf16 v[140:143], a[104:107], a[144:147], v[140:143]
    v_mfma_f32_16x16x32_bf16 v[140:143], a[108:111], a[148:151], v[140:143]
    v_mfma_f32_16x16x32_bf16 v[140:143], a[120:123], a[152:155], v[140:143]
    v_mfma_f32_16x16x32_bf16 v[140:143], a[124:127], a[156:159], v[140:143]
    v_mfma_f32_16x16x32_bf16 v[152:155], a[64:67], a[160:163], 0
    v_mfma_f32_16x16x32_bf16 v[152:155], a[68:71], a[164:167], v[152:155]
    s_waitcnt vmcnt(24)
    ds_read_b64_tr_b16 a[32:33], v30 offset:0
    v_mfma_f32_16x16x32_bf16 v[152:155], a[80:83], a[168:171], v[152:155]
    ds_read_b64_tr_b16 a[34:35], v30 offset:1024
    v_mfma_f32_16x16x32_bf16 v[152:155], a[84:87], a[172:175], v[152:155]
    ds_read_b64_tr_b16 a[36:37], v30 offset:2048
    v_mfma_f32_16x16x32_bf16 v[152:155], a[96:99], a[176:179], v[152:155]
    ds_read_b64_tr_b16 a[38:39], v30 offset:3072
    v_cvt_pk_bf16_f32 v72, v136, v137
    v_cvt_pk_bf16_f32 v73, v138, v139
    v_mfma_f32_16x16x32_bf16 v[152:155], a[100:103], a[180:183], v[152:155]
    s_add_u32 s63, s17, 0
    v_cvt_pk_bf16_f32 v74, v140, v141
    v_cvt_pk_bf16_f32 v75, v142, v143
    v_mfma_f32_16x16x32_bf16 v[152:155], a[112:115], a[184:187], v[152:155]
    ds_read_b64_tr_b16 a[40:41], v31 offset:0
    v_mfma_f32_16x16x32_bf16 v[152:155], a[116:119], a[188:191], v[152:155]
    ds_read_b64_tr_b16 a[42:43], v31 offset:1024
    buffer_store_dwordx4 v[72:75], v5, s[24:27], s63 offen sc1
    v_mfma_f32_16x16x32_bf16 v[156:159], a[72:75], a[160:163], 0
    ds_read_b64_tr_b16 a[44:45], v31 offset:2048
    v_mfma_f32_16x16x32_bf16 v[156:159], a[76:79], a[164:167], v[156:159]
    ds_read_b64_tr_b16 a[46:47], v31 offset:3072
    v_mfma_f32_16x16x32_bf16 v[156:159], a[88:91], a[168:171], v[156:159]
    v_mfma_f32_16x16x32_bf16 v[156:159], a[92:95], a[172:175], v[156:159]
    v_mfma_f32_16x16x32_bf16 v[156:159], a[104:107], a[176:179], v[156:159]
    v_mfma_f32_16x16x32_bf16 v[156:159], a[108:111], a[180:183], v[156:159]
    v_mfma_f32_16x16x32_bf16 v[156:159], a[120:123], a[184:187], v[156:159]
    v_mfma_f32_16x16x32_bf16 v[156:159], a[124:127], a[188:191], v[156:159]
    v_mfma_f32_16x16x32_bf16 v[168:171], a[64:67], v[192:195], 0
    v_lshl_add_u32 v34, v34, 16, v35
    v_mfma_f32_16x16x32_bf16 v[168:171], a[68:71], v[196:199], v[168:171]
    s_waitcnt vmcnt(21)
    ds_read_b64_tr_b16 a[48:49], v28 offset:0
    v_lshlrev_b32 v35, 11, v4
    v_mfma_f32_16x16x32_bf16 v[168:171], a[80:83], v[200:203], v[168:171]
    ds_read_b64_tr_b16 a[50:51], v28 offset:1024
    v_lshl_add_u32 v35, v1, 6, v35
    v_mfma_f32_16x16x32_bf16 v[168:171], a[84:87], v[204:207], v[168:171]
    ds_read_b64_tr_b16 a[52:53], v28 offset:2048
    v_lshl_add_u32 v35, v3, 4, v35
    v_mfma_f32_16x16x32_bf16 v[168:171], a[96:99], v[208:211], v[168:171]
    ds_read_b64_tr_b16 a[54:55], v28 offset:3072
    v_cvt_pk_bf16_f32 v76, v152, v153
    v_cvt_pk_bf16_f32 v77, v154, v155
    v_mfma_f32_16x16x32_bf16 v[168:171], a[100:103], v[212:215], v[168:171]
    s_add_u32 s63, s17, 65536
    v_cvt_pk_bf16_f32 v78, v156, v157
    v_cvt_pk_bf16_f32 v79, v158, v159
    v_mfma_f32_16x16x32_bf16 v[168:171], a[112:115], v[216:219], v[168:171]
    ds_read_b64_tr_b16 a[56:57], v29 offset:0
    v_lshlrev_b32 v6, 8, v0
    v_mfma_f32_16x16x32_bf16 v[168:171], a[116:119], v[220:223], v[168:171]
    ds_read_b64_tr_b16 a[58:59], v29 offset:1024
    buffer_store_dwordx4 v[76:79], v5, s[24:27], s63 offen sc1
    v_mfma_f32_16x16x32_bf16 v[172:175], a[72:75], v[192:195], 0
    ds_read_b64_tr_b16 a[60:61], v29 offset:2048
    v_mov_b32 v9, 1
    v_mfma_f32_16x16x32_bf16 v[172:175], a[76:79], v[196:199], v[172:175]
    ds_read_b64_tr_b16 a[62:63], v29 offset:3072
    v_mov_b32 v7, 0x100
    v_mfma_f32_16x16x32_bf16 v[172:175], a[88:91], v[200:203], v[172:175]
    v_mov_b32 v12, 0
    v_mfma_f32_16x16x32_bf16 v[172:175], a[92:95], v[204:207], v[172:175]
    v_mov_b32 v13, 0
    v_mfma_f32_16x16x32_bf16 v[172:175], a[104:107], v[208:211], v[172:175]
    v_mfma_f32_16x16x32_bf16 v[172:175], a[108:111], v[212:215], v[172:175]
    v_mfma_f32_16x16x32_bf16 v[172:175], a[120:123], v[216:219], v[172:175]
    v_mfma_f32_16x16x32_bf16 v[172:175], a[124:127], v[220:223], v[172:175]
    v_mfma_f32_16x16x32_bf16 v[184:187], a[64:67], v[224:227], 0
    v_mfma_f32_16x16x32_bf16 v[184:187], a[68:71], v[228:231], v[184:187]
    s_waitcnt vmcnt(18)
    ds_read_b64_tr_b16 a[192:193], v32 offset:16384
    v_mfma_f32_16x16x32_bf16 v[184:187], a[80:83], v[232:235], v[184:187]
    ds_read_b64_tr_b16 a[194:195], v32 offset:17408
    v_mfma_f32_16x16x32_bf16 v[184:187], a[84:87], v[236:239], v[184:187]
    ds_read_b64_tr_b16 a[196:197], v32 offset:18432
    v_mfma_f32_16x16x32_bf16 v[184:187], a[96:99], v[240:243], v[184:187]
    ds_read_b64_tr_b16 a[198:199], v32 offset:19456
    v_cvt_pk_bf16_f32 v80, v168, v169
    v_cvt_pk_bf16_f32 v81, v170, v171
    v_mfma_f32_16x16x32_bf16 v[184:187], a[100:103], v[244:247], v[184:187]
    s_add_u32 s63, s17, 131072
    v_cvt_pk_bf16_f32 v82, v172, v173
    v_cvt_pk_bf16_f32 v83, v174, v175
    v_mfma_f32_16x16x32_bf16 v[184:187], a[112:115], v[248:251], v[184:187]
    ds_read_b64_tr_b16 a[200:201], v33 offset:16384
    v_mfma_f32_16x16x32_bf16 v[184:187], a[116:119], v[252:255], v[184:187]
    ds_read_b64_tr_b16 a[202:203], v33 offset:17408
    buffer_store_dwordx4 v[80:83], v5, s[24:27], s63 offen sc1
    v_mfma_f32_16x16x32_bf16 v[188:191], a[72:75], v[224:227], 0
    ds_read_b64_tr_b16 a[204:205], v33 offset:18432
    v_mfma_f32_16x16x32_bf16 v[188:191], a[76:79], v[228:231], v[188:191]
    ds_read_b64_tr_b16 a[206:207], v33 offset:19456
    v_mfma_f32_16x16x32_bf16 v[188:191], a[88:91], v[232:235], v[188:191]
    v_mfma_f32_16x16x32_bf16 v[188:191], a[92:95], v[236:239], v[188:191]
    v_mfma_f32_16x16x32_bf16 v[188:191], a[104:107], v[240:243], v[188:191]
    v_mfma_f32_16x16x32_bf16 v[188:191], a[108:111], v[244:247], v[188:191]
    v_mfma_f32_16x16x32_bf16 v[188:191], a[120:123], v[248:251], v[188:191]
    v_mfma_f32_16x16x32_bf16 v[188:191], a[124:127], v[252:255], v[188:191]
    v_mfma_f32_16x16x32_bf16 v[128:131], a[0:3], a[128:131], 0
    v_mfma_f32_16x16x32_bf16 v[128:131], a[4:7], a[132:135], v[128:131]
    s_waitcnt lgkmcnt(0)
    s_waitcnt vmcnt(15)
    ds_read_b64_tr_b16 a[208:209], v28 offset:16384
    v_mfma_f32_16x16x32_bf16 v[128:131], a[16:19], a[136:139], v[128:131]
    ds_read_b64_tr_b16 a[210:211], v28 offset:17408
    v_mfma_f32_16x16x32_bf16 v[128:131], a[20:23], a[140:143], v[128:131]
    ds_read_b64_tr_b16 a[212:213], v28 offset:18432
    v_mfma_f32_16x16x32_bf16 v[128:131], a[32:35], a[144:147], v[128:131]
    ds_read_b64_tr_b16 a[214:215], v28 offset:19456
    v_cvt_pk_bf16_f32 v84, v184, v185
    v_cvt_pk_bf16_f32 v85, v186, v187
    v_mfma_f32_16x16x32_bf16 v[128:131], a[36:39], a[148:151], v[128:131]
    s_add_u32 s63, s17, 196608
    v_cvt_pk_bf16_f32 v86, v188, v189
    v_cvt_pk_bf16_f32 v87, v190, v191
    v_mfma_f32_16x16x32_bf16 v[128:131], a[48:51], a[152:155], v[128:131]
    ds_read_b64_tr_b16 a[216:217], v29 offset:16384
    v_mfma_f32_16x16x32_bf16 v[128:131], a[52:55], a[156:159], v[128:131]
    ds_read_b64_tr_b16 a[218:219], v29 offset:17408
    buffer_store_dwordx4 v[84:87], v5, s[24:27], s63 offen sc1
    v_mfma_f32_16x16x32_bf16 v[132:135], a[8:11], a[128:131], 0
    ds_read_b64_tr_b16 a[220:221], v29 offset:18432
    v_mfma_f32_16x16x32_bf16 v[132:135], a[12:15], a[132:135], v[132:135]
    ds_read_b64_tr_b16 a[222:223], v29 offset:19456
    v_mfma_f32_16x16x32_bf16 v[132:135], a[24:27], a[136:139], v[132:135]
    v_mfma_f32_16x16x32_bf16 v[132:135], a[28:31], a[140:143], v[132:135]
    v_mfma_f32_16x16x32_bf16 v[132:135], a[40:43], a[144:147], v[132:135]
    v_mfma_f32_16x16x32_bf16 v[132:135], a[44:47], a[148:151], v[132:135]
    v_mfma_f32_16x16x32_bf16 v[132:135], a[56:59], a[152:155], v[132:135]
    v_mfma_f32_16x16x32_bf16 v[132:135], a[60:63], a[156:159], v[132:135]
    v_mfma_f32_16x16x32_bf16 v[144:147], a[0:3], a[160:163], 0
    v_mfma_f32_16x16x32_bf16 v[144:147], a[4:7], a[164:167], v[144:147]
    s_waitcnt vmcnt(10)
    ds_read_b64_tr_b16 a[224:225], v28 offset:32768
    v_mfma_f32_16x16x32_bf16 v[144:147], a[16:19], a[168:171], v[144:147]
    ds_read_b64_tr_b16 a[226:227], v28 offset:33792
    v_mfma_f32_16x16x32_bf16 v[144:147], a[20:23], a[172:175], v[144:147]
    ds_read_b64_tr_b16 a[228:229], v28 offset:34816
    v_mfma_f32_16x16x32_bf16 v[144:147], a[32:35], a[176:179], v[144:147]
    ds_read_b64_tr_b16 a[230:231], v28 offset:35840
    v_cvt_pk_bf16_f32 v56, v128, v129
    v_cvt_pk_bf16_f32 v57, v130, v131
    v_mfma_f32_16x16x32_bf16 v[144:147], a[36:39], a[180:183], v[144:147]
    s_add_u32 s63, s18, 0
    v_cvt_pk_bf16_f32 v58, v132, v133
    v_cvt_pk_bf16_f32 v59, v134, v135
    v_mfma_f32_16x16x32_bf16 v[144:147], a[48:51], a[184:187], v[144:147]
    ds_read_b64_tr_b16 a[232:233], v29 offset:32768
    v_mfma_f32_16x16x32_bf16 v[144:147], a[52:55], a[188:191], v[144:147]
    ds_read_b64_tr_b16 a[234:235], v29 offset:33792
    buffer_store_dwordx4 v[56:59], v5, s[24:27], s63 offen sc1
    v_mfma_f32_16x16x32_bf16 v[148:151], a[8:11], a[160:163], 0
    ds_read_b64_tr_b16 a[236:237], v29 offset:34816
    v_mfma_f32_16x16x32_bf16 v[148:151], a[12:15], a[164:167], v[148:151]
    ds_read_b64_tr_b16 a[238:239], v29 offset:35840
    v_mfma_f32_16x16x32_bf16 v[148:151], a[24:27], a[168:171], v[148:151]
    v_mfma_f32_16x16x32_bf16 v[148:151], a[28:31], a[172:175], v[148:151]
    v_mfma_f32_16x16x32_bf16 v[148:151], a[40:43], a[176:179], v[148:151]
    v_mfma_f32_16x16x32_bf16 v[148:151], a[44:47], a[180:183], v[148:151]
    v_mfma_f32_16x16x32_bf16 v[148:151], a[56:59], a[184:187], v[148:151]
    v_mfma_f32_16x16x32_bf16 v[148:151], a[60:63], a[188:191], v[148:151]
    v_mfma_f32_16x16x32_bf16 v[160:163], a[0:3], v[192:195], 0
    v_mfma_f32_16x16x32_bf16 v[160:163], a[4:7], v[196:199], v[160:163]
    s_waitcnt vmcnt(6)
    ds_read_b64_tr_b16 a[240:241], v32 offset:0
    v_mfma_f32_16x16x32_bf16 v[160:163], a[16:19], v[200:203], v[160:163]
    ds_read_b64_tr_b16 a[242:243], v32 offset:1024
    v_mfma_f32_16x16x32_bf16 v[160:163], a[20:23], v[204:207], v[160:163]
    ds_read_b64_tr_b16 a[244:245], v32 offset:2048
    v_mfma_f32_16x16x32_bf16 v[160:163], a[32:35], v[208:211], v[160:163]
    ds_read_b64_tr_b16 a[246:247], v32 offset:3072
    v_cvt_pk_bf16_f32 v60, v144, v145
    v_cvt_pk_bf16_f32 v61, v146, v147
    v_mfma_f32_16x16x32_bf16 v[160:163], a[36:39], v[212:215], v[160:163]
    s_add_u32 s63, s18, 65536
    v_cvt_pk_bf16_f32 v62, v148, v149
    v_cvt_pk_bf16_f32 v63, v150, v151
    v_mfma_f32_16x16x32_bf16 v[160:163], a[48:51], v[216:219], v[160:163]
    ds_read_b64_tr_b16 a[248:249], v33 offset:0
    v_mfma_f32_16x16x32_bf16 v[160:163], a[52:55], v[220:223], v[160:163]
    ds_read_b64_tr_b16 a[250:251], v33 offset:1024
    buffer_store_dwordx4 v[60:63], v5, s[24:27], s63 offen sc1
    v_mfma_f32_16x16x32_bf16 v[164:167], a[8:11], v[192:195], 0
    ds_read_b64_tr_b16 a[252:253], v33 offset:2048
    v_mfma_f32_16x16x32_bf16 v[164:167], a[12:15], v[196:199], v[164:167]
    ds_read_b64_tr_b16 a[254:255], v33 offset:3072
    v_mfma_f32_16x16x32_bf16 v[164:167], a[24:27], v[200:203], v[164:167]
    v_mfma_f32_16x16x32_bf16 v[164:167], a[28:31], v[204:207], v[164:167]
    v_mfma_f32_16x16x32_bf16 v[164:167], a[40:43], v[208:211], v[164:167]
    v_mfma_f32_16x16x32_bf16 v[164:167], a[44:47], v[212:215], v[164:167]
    v_mfma_f32_16x16x32_bf16 v[164:167], a[56:59], v[216:219], v[164:167]
    v_mfma_f32_16x16x32_bf16 v[164:167], a[60:63], v[220:223], v[164:167]
    v_mfma_f32_16x16x32_bf16 v[176:179], a[0:3], v[224:227], 0
    v_mfma_f32_16x16x32_bf16 v[176:179], a[4:7], v[228:231], v[176:179]
    v_mfma_f32_16x16x32_bf16 v[176:179], a[16:19], v[232:235], v[176:179]
    v_mfma_f32_16x16x32_bf16 v[176:179], a[20:23], v[236:239], v[176:179]
    v_mfma_f32_16x16x32_bf16 v[176:179], a[32:35], v[240:243], v[176:179]
    v_cvt_pk_bf16_f32 v64, v160, v161
    v_cvt_pk_bf16_f32 v65, v162, v163
    v_mfma_f32_16x16x32_bf16 v[176:179], a[36:39], v[244:247], v[176:179]
    s_add_u32 s63, s18, 131072
    v_cvt_pk_bf16_f32 v66, v164, v165
    v_cvt_pk_bf16_f32 v67, v166, v167
    v_mfma_f32_16x16x32_bf16 v[176:179], a[48:51], v[248:251], v[176:179]
    v_mfma_f32_16x16x32_bf16 v[176:179], a[52:55], v[252:255], v[176:179]
    buffer_store_dwordx4 v[64:67], v5, s[24:27], s63 offen sc1
    v_mfma_f32_16x16x32_bf16 v[180:183], a[8:11], v[224:227], 0
    v_mfma_f32_16x16x32_bf16 v[180:183], a[12:15], v[228:231], v[180:183]
    v_mfma_f32_16x16x32_bf16 v[180:183], a[24:27], v[232:235], v[180:183]
    v_mfma_f32_16x16x32_bf16 v[180:183], a[28:31], v[236:239], v[180:183]
    v_mfma_f32_16x16x32_bf16 v[180:183], a[40:43], v[240:243], v[180:183]
    v_mfma_f32_16x16x32_bf16 v[180:183], a[44:47], v[244:247], v[180:183]
    v_mfma_f32_16x16x32_bf16 v[180:183], a[56:59], v[248:251], v[180:183]
    v_mfma_f32_16x16x32_bf16 v[180:183], a[60:63], v[252:255], v[180:183]
    v_mfma_f32_16x16x32_bf16 v[136:139], a[192:195], a[128:131], 0
    v_mfma_f32_16x16x32_bf16 v[136:139], a[196:199], a[132:135], v[136:139]
    s_waitcnt lgkmcnt(0)
    v_mfma_f32_16x16x32_bf16 v[136:139], a[208:211], a[136:139], v[136:139]
    v_mfma_f32_16x16x32_bf16 v[136:139], a[212:215], a[140:143], v[136:139]
    v_mfma_f32_16x16x32_bf16 v[136:139], a[224:227], a[144:147], v[136:139]
    s_waitcnt vmcnt(3)
    v_cvt_pk_bf16_f32 v68, v176, v177
    v_cvt_pk_bf16_f32 v69, v178, v179
    v_mfma_f32_16x16x32_bf16 v[136:139], a[228:231], a[148:151], v[136:139]
    s_add_u32 s63, s18, 196608
    s_barrier
    buffer_atomic_add v9, v6, s[56:59], 0 offen sc1
    v_cvt_pk_bf16_f32 v70, v180, v181
    v_cvt_pk_bf16_f32 v71, v182, v183
    v_mfma_f32_16x16x32_bf16 v[136:139], a[240:243], a[152:155], v[136:139]
    v_mfma_f32_16x16x32_bf16 v[136:139], a[244:247], a[156:159], v[136:139]
    buffer_store_dwordx4 v[68:71], v5, s[24:27], s63 offen sc1
    v_mfma_f32_16x16x32_bf16 v[140:143], a[200:203], a[128:131], 0
    v_mfma_f32_16x16x32_bf16 v[140:143], a[204:207], a[132:135], v[140:143]
    v_mfma_f32_16x16x32_bf16 v[140:143], a[216:219], a[136:139], v[140:143]
    v_mfma_f32_16x16x32_bf16 v[140:143], a[220:223], a[140:143], v[140:143]
    v_mfma_f32_16x16x32_bf16 v[140:143], a[232:235], a[144:147], v[140:143]
    v_mfma_f32_16x16x32_bf16 v[140:143], a[236:239], a[148:151], v[140:143]
    v_mfma_f32_16x16x32_bf16 v[140:143], a[248:251], a[152:155], v[140:143]
    v_mfma_f32_16x16x32_bf16 v[140:143], a[252:255], a[156:159], v[140:143]
    v_mfma_f32_16x16x32_bf16 v[152:155], a[192:195], a[160:163], 0
    v_mfma_f32_16x16x32_bf16 v[152:155], a[196:199], a[164:167], v[152:155]
    v_mfma_f32_16x16x32_bf16 v[152:155], a[208:211], a[168:171], v[152:155]
    v_mfma_f32_16x16x32_bf16 v[152:155], a[212:215], a[172:175], v[152:155]
    v_mfma_f32_16x16x32_bf16 v[152:155], a[224:227], a[176:179], v[152:155]
    v_cvt_pk_bf16_f32 v72, v136, v137
    v_cvt_pk_bf16_f32 v73, v138, v139
    v_mfma_f32_16x16x32_bf16 v[152:155], a[228:231], a[180:183], v[152:155]
    s_add_u32 s63, s19, 0
    v_cvt_pk_bf16_f32 v74, v140, v141
    v_cvt_pk_bf16_f32 v75, v142, v143
    v_mfma_f32_16x16x32_bf16 v[152:155], a[240:243], a[184:187], v[152:155]
    v_mfma_f32_16x16x32_bf16 v[152:155], a[244:247], a[188:191], v[152:155]
    buffer_store_dwordx4 v[72:75], v5, s[24:27], s63 offen sc1
    v_mfma_f32_16x16x32_bf16 v[156:159], a[200:203], a[160:163], 0
    v_mfma_f32_16x16x32_bf16 v[156:159], a[204:207], a[164:167], v[156:159]
    v_mfma_f32_16x16x32_bf16 v[156:159], a[216:219], a[168:171], v[156:159]
    v_mfma_f32_16x16x32_bf16 v[156:159], a[220:223], a[172:175], v[156:159]
    v_mfma_f32_16x16x32_bf16 v[156:159], a[232:235], a[176:179], v[156:159]
    v_mfma_f32_16x16x32_bf16 v[156:159], a[236:239], a[180:183], v[156:159]
    v_mfma_f32_16x16x32_bf16 v[156:159], a[248:251], a[184:187], v[156:159]
    v_mfma_f32_16x16x32_bf16 v[156:159], a[252:255], a[188:191], v[156:159]
    v_mfma_f32_16x16x32_bf16 v[168:171], a[192:195], v[192:195], 0
    v_mfma_f32_16x16x32_bf16 v[168:171], a[196:199], v[196:199], v[168:171]
    v_mfma_f32_16x16x32_bf16 v[168:171], a[208:211], v[200:203], v[168:171]
    v_mfma_f32_16x16x32_bf16 v[168:171], a[212:215], v[204:207], v[168:171]
    v_mfma_f32_16x16x32_bf16 v[168:171], a[224:227], v[208:211], v[168:171]
    v_cvt_pk_bf16_f32 v76, v152, v153
    v_cvt_pk_bf16_f32 v77, v154, v155
    v_mfma_f32_16x16x32_bf16 v[168:171], a[228:231], v[212:215], v[168:171]
    s_add_u32 s63, s19, 65536
    v_cvt_pk_bf16_f32 v78, v156, v157
    v_cvt_pk_bf16_f32 v79, v158, v159
    v_mfma_f32_16x16x32_bf16 v[168:171], a[240:243], v[216:219], v[168:171]
    v_mfma_f32_16x16x32_bf16 v[168:171], a[244:247], v[220:223], v[168:171]
    buffer_store_dwordx4 v[76:79], v5, s[24:27], s63 offen sc1
    v_mfma_f32_16x16x32_bf16 v[172:175], a[200:203], v[192:195], 0
    v_mfma_f32_16x16x32_bf16 v[172:175], a[204:207], v[196:199], v[172:175]
    v_mfma_f32_16x16x32_bf16 v[172:175], a[216:219], v[200:203], v[172:175]
    v_mfma_f32_16x16x32_bf16 v[172:175], a[220:223], v[204:207], v[172:175]
    v_mfma_f32_16x16x32_bf16 v[172:175], a[232:235], v[208:211], v[172:175]
    v_mfma_f32_16x16x32_bf16 v[172:175], a[236:239], v[212:215], v[172:175]
    v_mfma_f32_16x16x32_bf16 v[172:175], a[248:251], v[216:219], v[172:175]
    v_mfma_f32_16x16x32_bf16 v[172:175], a[252:255], v[220:223], v[172:175]
    v_mfma_f32_16x16x32_bf16 v[184:187], a[192:195], v[224:227], 0
    v_mfma_f32_16x16x32_bf16 v[184:187], a[196:199], v[228:231], v[184:187]
    v_mfma_f32_16x16x32_bf16 v[184:187], a[208:211], v[232:235], v[184:187]
    v_mfma_f32_16x16x32_bf16 v[184:187], a[212:215], v[236:239], v[184:187]
    v_mfma_f32_16x16x32_bf16 v[184:187], a[224:227], v[240:243], v[184:187]
    v_cvt_pk_bf16_f32 v80, v168, v169
    v_cvt_pk_bf16_f32 v81, v170, v171
    v_mfma_f32_16x16x32_bf16 v[184:187], a[228:231], v[244:247], v[184:187]
    s_add_u32 s63, s19, 131072
    v_cvt_pk_bf16_f32 v82, v172, v173
    v_cvt_pk_bf16_f32 v83, v174, v175
    v_mfma_f32_16x16x32_bf16 v[184:187], a[240:243], v[248:251], v[184:187]
    v_mfma_f32_16x16x32_bf16 v[184:187], a[244:247], v[252:255], v[184:187]
    buffer_store_dwordx4 v[80:83], v5, s[24:27], s63 offen sc1
    v_mfma_f32_16x16x32_bf16 v[188:191], a[200:203], v[224:227], 0
    v_mfma_f32_16x16x32_bf16 v[188:191], a[204:207], v[228:231], v[188:191]
    v_mfma_f32_16x16x32_bf16 v[188:191], a[216:219], v[232:235], v[188:191]
    v_mfma_f32_16x16x32_bf16 v[188:191], a[220:223], v[236:239], v[188:191]
    v_mfma_f32_16x16x32_bf16 v[188:191], a[232:235], v[240:243], v[188:191]
    v_mfma_f32_16x16x32_bf16 v[188:191], a[236:239], v[244:247], v[188:191]
    v_mfma_f32_16x16x32_bf16 v[188:191], a[248:251], v[248:251], v[188:191]
    v_mfma_f32_16x16x32_bf16 v[188:191], a[252:255], v[252:255], v[188:191]
    s_add_u32 s63, s19, 196608
    v_cvt_pk_bf16_f32 v84, v184, v185
    v_cvt_pk_bf16_f32 v85, v186, v187
    s_nop 4
    v_cvt_pk_bf16_f32 v86, v188, v189
    v_cvt_pk_bf16_f32 v87, v190, v191
    buffer_store_dwordx4 v[84:87], v5, s[24:27], s63 offen sc1
    buffer_atomic_or v12, v6, s[56:59], 0 offen sc0 sc1
    s_mov_b32 s31, 0
    s_cmp_eq_u32 s28, 0
    s_waitcnt vmcnt(1)
    s_barrier
    buffer_atomic_add v7, v6, s[56:59], 0 offen sc0 sc1
    s_cbranch_scc0 L_gotA
    s_waitcnt vmcnt(1)
    v_readfirstlane_b32 s65, v12
    s_nop 0
    s_bitcmp1_b32 s65, 4
    s_cbranch_scc1 L_gotA
    s_waitcnt vmcnt(0)
    v_readfirstlane_b32 s65, v7
    s_nop 0
    s_bitcmp1_b32 s65, 4
    s_cbranch_scc1 L_gotA
L_pollA:
    v_mov_b32 v8, 0
    buffer_atomic_or v8, v6, s[56:59], 0 offen sc0 sc1
    s_add_u32 s31, s31, 1
    s_waitcnt vmcnt(0)
    v_readfirstlane_b32 s65, v8
    s_cmp_ge_u32 s31, 0x80000
    s_cbranch_scc1 L_gotA
    s_bitcmp1_b32 s65, 4
    s_cbranch_scc0 L_pollA
L_gotA:
    s_barrier
    s_sub_u32 s66, s35, 0
    s_and_b32 s66, s66, 12
    s_add_u32 s63, s35, 1
    s_and_b32 s63, s63, 3
    s_or_b32 s63, s63, s66
    s_lshl_b32 s63, s63, 10
    buffer_load_dwordx4 v[196:199], v34, s[24:27], s63 offen sc1 nt
    s_add_u32 s63, s35, 2
    s_and_b32 s63, s63, 3
    s_or_b32 s63, s63, s66
    s_lshl_b32 s63, s63, 10
    buffer_load_dwordx4 v[200:203], v34, s[24:27], s63 offen sc1 nt
    s_add_u32 s63, s35, 3
    s_and_b32 s63, s63, 3
    s_or_b32 s63, s63, s66
    s_lshl_b32 s63, s63, 10
    buffer_load_dwordx4 v[204:207], v34, s[24:27], s63 offen sc1 nt
    s_sub_u32 s66, s35, 4
    s_and_b32 s66, s66, 12
    s_add_u32 s63, s35, 0
    s_and_b32 s63, s63, 3
    s_or_b32 s63, s63, s66
    s_lshl_b32 s63, s63, 10
    buffer_load_dwordx4 v[208:211], v34, s[24:27], s63 offen sc1 nt
    s_add_u32 s63, s35, 1
    s_and_b32 s63, s63, 3
    s_or_b32 s63, s63, s66
    s_lshl_b32 s63, s63, 10
    buffer_load_dwordx4 v[212:215], v34, s[24:27], s63 offen sc1 nt
    s_add_u32 s63, s35, 2
    s_and_b32 s63, s63, 3
    s_or_b32 s63, s63, s66
    s_lshl_b32 s63, s63, 10
    buffer_load_dwordx4 v[216:219], v34, s[24:27], s63 offen sc1 nt
    s_add_u32 s63, s35, 3
    s_and_b32 s63, s63, 3
    s_or_b32 s63, s63, s66
    s_lshl_b32 s63, s63, 10
    buffer_load_dwordx4 v[220:223], v34, s[24:27], s63 offen sc1 nt
    s_cmp_eq_u32 s28, 0
    s_cbranch_scc0 L_gotB
    buffer_atomic_or v13, v6, s[56:59], 0 offen sc0 sc1
    s_waitcnt vmcnt(8)
    v_readfirstlane_b32 s65, v7
    s_nop 0
    s_lshr_b32 s65, s65, 8
    s_cmp_eq_u32 s65, 15
    s_cbranch_scc1 L_gotB
    s_waitcnt vmcnt(0)
    v_readfirstlane_b32 s65, v13
    s_nop 0
    s_bitcmp1_b32 s65, 12
    s_cbranch_scc1 L_gotB
L_pollB:
    v_mov_b32 v8, 0
    buffer_atomic_or v8, v6, s[56:59], 0 offen sc0 sc1
    s_add_u32 s31, s31, 1
    s_waitcnt vmcnt(0)
    v_readfirstlane_b32 s65, v8
    s_cmp_ge_u32 s31, 0x80000
    s_cbranch_scc1 L_gotB
    s_bitcmp1_b32 s65, 12
    s_cbranch_scc0 L_pollB
L_gotB:
    s_barrier
    s_sub_u32 s66, s35, 8
    s_and_b32 s66, s66, 12
    s_add_u32 s63, s35, 0
    s_and_b32 s63, s63, 3
    s_or_b32 s63, s63, s66
    s_lshl_b32 s63, s63, 10
    buffer_load_dwordx4 v[224:227], v34, s[24:27], s63 offen sc1 nt
    s_add_u32 s63, s35, 1
    s_and_b32 s63, s63, 3
    s_or_b32 s63, s63, s66
    s_lshl_b32 s63, s63, 10
    buffer_load_dwordx4 v[228:231], v34, s[24:27], s63 offen sc1 nt
    s_add_u32 s63, s35, 2
    s_and_b32 s63, s63, 3
    s_or_b32 s63, s63, s66
    s_lshl_b32 s63, s63, 10
    buffer_load_dwordx4 v[232:235], v34, s[24:27], s63 offen sc1 nt
    s_add_u32 s63, s35, 3
    s_and_b32 s63, s63, 3
    s_or_b32 s63, s63, s66
    s_lshl_b32 s63, s63, 10
    buffer_load_dwordx4 v[236:239], v34, s[24:27], s63 offen sc1 nt
    s_sub_u32 s66, s35, 12
    s_and_b32 s66, s66, 12
    s_add_u32 s63, s35, 0
    s_and_b32 s63, s63, 3
    s_or_b32 s63, s63, s66
    s_lshl_b32 s63, s63, 10
    buffer_load_dwordx4 v[240:243], v34, s[24:27], s63 offen sc1 nt
    s_add_u32 s63, s35, 1
    s_and_b32 s63, s63, 3
    s_or_b32 s63, s63, s66
    s_lshl_b32 s63, s63, 10
    buffer_load_dwordx4 v[244:247], v34, s[24:27], s63 offen sc1 nt
    s_add_u32 s63, s35, 2
    s_and_b32 s63, s63, 3
    s_or_b32 s63, s63, s66
    s_lshl_b32 s63, s63, 10
    buffer_load_dwordx4 v[248:251], v34, s[24:27], s63 offen sc1 nt
    s_add_u32 s63, s35, 3
    s_and_b32 s63, s63, 3
    s_or_b32 s63, s63, s66
    s_lshl_b32 s63, s63, 10
    buffer_load_dwordx4 v[252:255], v34, s[24:27], s63 offen sc1 nt
    v_lshlrev_b32 v16, 16, v88
    v_and_b32 v17, 0xffff0000, v88
    v_lshlrev_b32 v18, 16, v89
    v_and_b32 v19, 0xffff0000, v89
    v_lshlrev_b32 v20, 16, v90
    v_and_b32 v21, 0xffff0000, v90
    v_lshlrev_b32 v22, 16, v91
    v_and_b32 v23, 0xffff0000, v91
    s_waitcnt vmcnt(14)
    v_lshlrev_b32 v24, 16, v196
    v_and_b32 v25, 0xffff0000, v196
    v_pk_add_f32 v[16:17], v[16:17], v[24:25]
    v_lshlrev_b32 v26, 16, v197
    v_and_b32 v27, 0xffff0000, v197
    v_pk_add_f32 v[18:19], v[18:19], v[26:27]
    v_lshlrev_b32 v24, 16, v198
    v_and_b32 v25, 0xffff0000, v198
    v_pk_add_f32 v[20:21], v[20:21], v[24:25]
    v_lshlrev_b32 v26, 16, v199
    v_and_b32 v27, 0xffff0000, v199
    v_pk_add_f32 v[22:23], v[22:23], v[26:27]
    s_waitcnt vmcnt(13)
    v_lshlrev_b32 v24, 16, v200
    v_and_b32 v25, 0xffff0000, v200
    v_pk_add_f32 v[16:17], v[16:17], v[24:25]
    v_lshlrev_b32 v26, 16, v201
    v_and_b32 v27, 0xffff0000, v201
    v_pk_add_f32 v[18:19], v[18:19], v[26:27]
    v_lshlrev_b32 v24, 16, v202
    v_and_b32 v25, 0xffff0000, v202
    v_pk_add_f32 v[20:21], v[20:21], v[24:25]
    v_lshlrev_b32 v26, 16, v203
    v_and_b32 v27, 0xffff0000, v203
    v_pk_add_f32 v[22:23], v[22:23], v[26:27]
    s_waitcnt vmcnt(12)
    v_lshlrev_b32 v24, 16, v204
    v_and_b32 v25, 0xffff0000, v204
    v_pk_add_f32 v[16:17], v[16:17], v[24:25]
    v_lshlrev_b32 v26, 16, v205
    v_and_b32 v27, 0xffff0000, v205
    v_pk_add_f32 v[18:19], v[18:19], v[26:27]
    v_lshlrev_b32 v24, 16, v206
    v_and_b32 v25, 0xffff0000, v206
    v_pk_add_f32 v[20:21], v[20:21], v[24:25]
    v_lshlrev_b32 v26, 16, v207
    v_and_b32 v27, 0xffff0000, v207
    v_pk_add_f32 v[22:23], v[22:23], v[26:27]
    s_waitcnt vmcnt(11)
    v_lshlrev_b32 v24, 16, v208
    v_and_b32 v25, 0xffff0000, v208
    v_pk_add_f32 v[16:17], v[16:17], v[24:25]
    v_lshlrev_b32 v26, 16, v209
    v_and_b32 v27, 0xffff0000, v209
    v_pk_add_f32 v[18:19], v[18:19], v[26:27]
    v_lshlrev_b32 v24, 16, v210
    v_and_b32 v25, 0xffff0000, v210
    v_pk_add_f32 v[20:21], v[20:21], v[24:25]
    v_lshlrev_b32 v26, 16, v211
    v_and_b32 v27, 0xffff0000, v211
    v_pk_add_f32 v[22:23], v[22:23], v[26:27]
    s_waitcnt vmcnt(10)
    v_lshlrev_b32 v24, 16, v212
    v_and_b32 v25, 0xffff0000, v212
    v_pk_add_f32 v[16:17], v[16:17], v[24:25]
    v_lshlrev_b32 v26, 16, v213
    v_and_b32 v27, 0xffff0000, v213
    v_pk_add_f32 v[18:19], v[18:19], v[26:27]
    v_lshlrev_b32 v24, 16, v214
    v_and_b32 v25, 0xffff0000, v214
    v_pk_add_f32 v[20:21], v[20:21], v[24:25]
    v_lshlrev_b32 v26, 16, v215
    v_and_b32 v27, 0xffff0000, v215
    v_pk_add_f32 v[22:23], v[22:23], v[26:27]
    s_waitcnt vmcnt(9)
    v_lshlrev_b32 v24, 16, v216
    v_and_b32 v25, 0xffff0000, v216
    v_pk_add_f32 v[16:17], v[16:17], v[24:25]
    v_lshlrev_b32 v26, 16, v217
    v_and_b32 v27, 0xffff0000, v217
    v_pk_add_f32 v[18:19], v[18:19], v[26:27]
    v_lshlrev_b32 v24, 16, v218
    v_and_b32 v25, 0xffff0000, v218
    v_pk_add_f32 v[20:21], v[20:21], v[24:25]
    v_lshlrev_b32 v26, 16, v219
    v_and_b32 v27, 0xffff0000, v219
    v_pk_add_f32 v[22:23], v[22:23], v[26:27]
    s_waitcnt vmcnt(8)
    v_lshlrev_b32 v24, 16, v220
    v_and_b32 v25, 0xffff0000, v220
    v_pk_add_f32 v[16:17], v[16:17], v[24:25]
    v_lshlrev_b32 v26, 16, v221
    v_and_b32 v27, 0xffff0000, v221
    v_pk_add_f32 v[18:19], v[18:19], v[26:27]
    v_lshlrev_b32 v24, 16, v222
    v_and_b32 v25, 0xffff0000, v222
    v_pk_add_f32 v[20:21], v[20:21], v[24:25]
    v_lshlrev_b32 v26, 16, v223
    v_and_b32 v27, 0xffff0000, v223
    v_pk_add_f32 v[22:23], v[22:23], v[26:27]
    s_waitcnt vmcnt(7)
    v_lshlrev_b32 v24, 16, v224
    v_and_b32 v25, 0xffff0000, v224
    v_pk_add_f32 v[16:17], v[16:17], v[24:25]
    v_lshlrev_b32 v26, 16, v225
    v_and_b32 v27, 0xffff0000, v225
    v_pk_add_f32 v[18:19], v[18:19], v[26:27]
    v_lshlrev_b32 v24, 16, v226
    v_and_b32 v25, 0xffff0000, v226
    v_pk_add_f32 v[20:21], v[20:21], v[24:25]
    v_lshlrev_b32 v26, 16, v227
    v_and_b32 v27, 0xffff0000, v227
    v_pk_add_f32 v[22:23], v[22:23], v[26:27]
    s_waitcnt vmcnt(6)
    v_lshlrev_b32 v24, 16, v228
    v_and_b32 v25, 0xffff0000, v228
    v_pk_add_f32 v[16:17], v[16:17], v[24:25]
    v_lshlrev_b32 v26, 16, v229
    v_and_b32 v27, 0xffff0000, v229
    v_pk_add_f32 v[18:19], v[18:19], v[26:27]
    v_lshlrev_b32 v24, 16, v230
    v_and_b32 v25, 0xffff0000, v230
    v_pk_add_f32 v[20:21], v[20:21], v[24:25]
    v_lshlrev_b32 v26, 16, v231
    v_and_b32 v27, 0xffff0000, v231
    v_pk_add_f32 v[22:23], v[22:23], v[26:27]
    s_waitcnt vmcnt(5)
    v_lshlrev_b32 v24, 16, v232
    v_and_b32 v25, 0xffff0000, v232
    v_pk_add_f32 v[16:17], v[16:17], v[24:25]
    v_lshlrev_b32 v26, 16, v233
    v_and_b32 v27, 0xffff0000, v233
    v_pk_add_f32 v[18:19], v[18:19], v[26:27]
    v_lshlrev_b32 v24, 16, v234
    v_and_b32 v25, 0xffff0000, v234
    v_pk_add_f32 v[20:21], v[20:21], v[24:25]
    v_lshlrev_b32 v26, 16, v235
    v_and_b32 v27, 0xffff0000, v235
    v_pk_add_f32 v[22:23], v[22:23], v[26:27]
    s_waitcnt vmcnt(4)
    v_lshlrev_b32 v24, 16, v236
    v_and_b32 v25, 0xffff0000, v236
    v_pk_add_f32 v[16:17], v[16:17], v[24:25]
    v_lshlrev_b32 v26, 16, v237
    v_and_b32 v27, 0xffff0000, v237
    v_pk_add_f32 v[18:19], v[18:19], v[26:27]
    v_lshlrev_b32 v24, 16, v238
    v_and_b32 v25, 0xffff0000, v238
    v_pk_add_f32 v[20:21], v[20:21], v[24:25]
    v_lshlrev_b32 v26, 16, v239
    v_and_b32 v27, 0xffff0000, v239
    v_pk_add_f32 v[22:23], v[22:23], v[26:27]
    s_waitcnt vmcnt(3)
    v_lshlrev_b32 v24, 16, v240
    v_and_b32 v25, 0xffff0000, v240
    v_pk_add_f32 v[16:17], v[16:17], v[24:25]
    v_lshlrev_b32 v26, 16, v241
    v_and_b32 v27, 0xffff0000, v241
    v_pk_add_f32 v[18:19], v[18:19], v[26:27]
    v_lshlrev_b32 v24, 16, v242
    v_and_b32 v25, 0xffff0000, v242
    v_pk_add_f32 v[20:21], v[20:21], v[24:25]
    v_lshlrev_b32 v26, 16, v243
    v_and_b32 v27, 0xffff0000, v243
    v_pk_add_f32 v[22:23], v[22:23], v[26:27]
    s_waitcnt vmcnt(2)
    v_lshlrev_b32 v24, 16, v244
    v_and_b32 v25, 0xffff0000, v244
    v_pk_add_f32 v[16:17], v[16:17], v[24:25]
    v_lshlrev_b32 v26, 16, v245
    v_and_b32 v27, 0xffff0000, v245
    v_pk_add_f32 v[18:19], v[18:19], v[26:27]
    v_lshlrev_b32 v24, 16, v246
    v_and_b32 v25, 0xffff0000, v246
    v_pk_add_f32 v[20:21], v[20:21], v[24:25]
    v_lshlrev_b32 v26, 16, v247
    v_and_b32 v27, 0xffff0000, v247
    v_pk_add_f32 v[22:23], v[22:23], v[26:27]
    s_waitcnt vmcnt(1)
    v_lshlrev_b32 v24, 16, v248
    v_and_b32 v25, 0xffff0000, v248
    v_pk_add_f32 v[16:17], v[16:17], v[24:25]
    v_lshlrev_b32 v26, 16, v249
    v_and_b32 v27, 0xffff0000, v249
    v_pk_add_f32 v[18:19], v[18:19], v[26:27]
    v_lshlrev_b32 v24, 16, v250
    v_and_b32 v25, 0xffff0000, v250
    v_pk_add_f32 v[20:21], v[20:21], v[24:25]
    v_lshlrev_b32 v26, 16, v251
    v_and_b32 v27, 0xffff0000, v251
    v_pk_add_f32 v[22:23], v[22:23], v[26:27]
    s_waitcnt vmcnt(0)
    v_lshlrev_b32 v24, 16, v252
    v_and_b32 v25, 0xffff0000, v252
    v_pk_add_f32 v[16:17], v[16:17], v[24:25]
    v_lshlrev_b32 v26, 16, v253
    v_and_b32 v27, 0xffff0000, v253
    v_pk_add_f32 v[18:19], v[18:19], v[26:27]
    v_lshlrev_b32 v24, 16, v254
    v_and_b32 v25, 0xffff0000, v254
    v_pk_add_f32 v[20:21], v[20:21], v[24:25]
    v_lshlrev_b32 v26, 16, v255
    v_and_b32 v27, 0xffff0000, v255
    v_pk_add_f32 v[22:23], v[22:23], v[26:27]
    v_cvt_pk_bf16_f32 v8, v16, v17
    v_cvt_pk_bf16_f32 v9, v18, v19
    v_cvt_pk_bf16_f32 v10, v20, v21
    v_cvt_pk_bf16_f32 v11, v22, v23
    s_nop 0
    v_permlane32_swap_b32 v8, v10
    v_permlane32_swap_b32 v9, v11
    s_nop 0
    v_permlane16_swap_b32 v8, v10
    v_permlane16_swap_b32 v9, v11
    buffer_store_dwordx4 v[8:11], v35, s[4:7], s45 offen
L_end:
    s_endpgm
L_cntwait:
    s_mov_b32 s31, 0
L_cntspin:
    buffer_load_dword v35, v15, s[52:55], s40 offen sc1
    s_add_u32 s31, s31, 1
    s_cmp_lt_u32 s31, 0x100000
    s_waitcnt vmcnt(0)
    v_cmp_ne_u32 vcc, v34, v35
    s_cbranch_scc0 L_cntok
    s_cbranch_vccnz L_cntspin
    s_branch L_cntok
L_redo:
    s_cmp_lg_u32 s62, 0
    s_cbranch_scc1 L_noredo
    s_mov_b32 s62, 1
    s_waitcnt vmcnt(0) lgkmcnt(0)
    s_nop 7
    s_barrier
    s_mov_b32 s38, 0
    s_lshl_b32 s63, s29, 13
    v_subrev_u32 v124, s63, v16
    v_subrev_u32 v125, s63, v17
    v_subrev_u32 v126, s63, v18
    v_subrev_u32 v127, s63, v19
    v_mov_b32 v88, 0xff800000
    v_mov_b32 v89, 0xff800000
    v_mov_b32 v90, 0xff800000
    v_mov_b32 v91, 0xff800000
L_maxloop:
    s_xor_b32 s32, s38, s39
    s_add_u32 m0, s33, 32768
    s_nop 0
    buffer_load_dwordx4 v8, s[8:11], s32 offen offset:0 nt lds
    buffer_load_dwordx4 v9, s[8:11], s32 offen offset:1024 nt lds
    buffer_load_dwordx4 v10, s[8:11], s32 offen offset:2048 nt lds
    buffer_load_dwordx4 v11, s[8:11], s32 offen offset:3072 nt lds
    s_add_u32 s38, s38, 16384
    s_waitcnt vmcnt(0)
    s_barrier
    ds_read_b128 a[64:67], v124 offset:0
    ds_read_b128 a[68:71], v125 offset:0
    ds_read_b128 a[72:75], v126 offset:0
    ds_read_b128 a[76:79], v127 offset:0
    ds_read_b128 a[80:83], v124 offset:4096
    ds_read_b128 a[84:87], v125 offset:4096
    ds_read_b128 a[88:91], v126 offset:4096
    ds_read_b128 a[92:95], v127 offset:4096
    ds_read_b128 a[96:99], v124 offset:8192
    ds_read_b128 a[100:103], v125 offset:8192
    ds_read_b128 a[104:107], v126 offset:8192
    ds_read_b128 a[108:111], v127 offset:8192
    ds_read_b128 a[112:115], v124 offset:12288
    ds_read_b128 a[116:119], v125 offset:12288
    ds_read_b128 a[120:123], v126 offset:12288
    ds_read_b128 a[124:127], v127 offset:12288
    s_waitcnt lgkmcnt(0)
    s_barrier
    v_mfma_f32_16x16x32_bf16 v[56:59], a[64:67], a[0:3], 0
    v_mfma_f32_16x16x32_bf16 v[56:59], a[68:71], a[4:7], v[56:59]
    v_mfma_f32_16x16x32_bf16 v[56:59], a[72:75], a[8:11], v[56:59]
    v_mfma_f32_16x16x32_bf16 v[56:59], a[76:79], a[12:15], v[56:59]
    v_mfma_f32_16x16x32_bf16 v[60:63], a[80:83], a[0:3], 0
    v_mfma_f32_16x16x32_bf16 v[60:63], a[84:87], a[4:7], v[60:63]
    v_mfma_f32_16x16x32_bf16 v[60:63], a[88:91], a[8:11], v[60:63]
    v_mfma_f32_16x16x32_bf16 v[60:63], a[92:95], a[12:15], v[60:63]
    v_mfma_f32_16x16x32_bf16 v[64:67], a[96:99], a[0:3], 0
    v_mfma_f32_16x16x32_bf16 v[64:67], a[100:103], a[4:7], v[64:67]
    v_mfma_f32_16x16x32_bf16 v[64:67], a[104:107], a[8:11], v[64:67]
    v_mfma_f32_16x16x32_bf16 v[64:67], a[108:111], a[12:15], v[64:67]
    v_mfma_f32_16x16x32_bf16 v[68:71], a[112:115], a[0:3], 0
    v_mfma_f32_16x16x32_bf16 v[68:71], a[116:119], a[4:7], v[68:71]
    v_mfma_f32_16x16x32_bf16 v[68:71], a[120:123], a[8:11], v[68:71]
    v_mfma_f32_16x16x32_bf16 v[68:71], a[124:127], a[12:15], v[68:71]
    v_max3_f32 v88, v88, v56, v57
    v_max3_f32 v88, v88, v58, v59
    v_max3_f32 v88, v88, v60, v61
    v_max3_f32 v88, v88, v62, v63
    v_max3_f32 v88, v88, v64, v65
    v_max3_f32 v88, v88, v66, v67
    s_nop 1
    v_max3_f32 v88, v88, v68, v69
    v_max3_f32 v88, v88, v70, v71
    v_mfma_f32_16x16x32_bf16 v[56:59], a[64:67], a[16:19], 0
    v_mfma_f32_16x16x32_bf16 v[56:59], a[68:71], a[20:23], v[56:59]
    v_mfma_f32_16x16x32_bf16 v[56:59], a[72:75], a[24:27], v[56:59]
    v_mfma_f32_16x16x32_bf16 v[56:59], a[76:79], a[28:31], v[56:59]
    v_mfma_f32_16x16x32_bf16 v[60:63], a[80:83], a[16:19], 0
    v_mfma_f32_16x16x32_bf16 v[60:63], a[84:87], a[20:23], v[60:63]
    v_mfma_f32_16x16x32_bf16 v[60:63], a[88:91], a[24:27], v[60:63]
    v_mfma_f32_16x16x32_bf16 v[60:63], a[92:95], a[28:31], v[60:63]
    v_mfma_f32_16x16x32_bf16 v[64:67], a[96:99], a[16:19], 0
    v_mfma_f32_16x16x32_bf16 v[64:67], a[100:103], a[20:23], v[64:67]
    v_mfma_f32_16x16x32_bf16 v[64:67], a[104:107], a[24:27], v[64:67]
    v_mfma_f32_16x16x32_bf16 v[64:67], a[108:111], a[28:31], v[64:67]
    v_mfma_f32_16x16x32_bf16 v[68:71], a[112:115], a[16:19], 0
    v_mfma_f32_16x16x32_bf16 v[68:71], a[116:119], a[20:23], v[68:71]
    v_mfma_f32_16x16x32_bf16 v[68:71], a[120:123], a[24:27], v[68:71]
    v_mfma_f32_16x16x32_bf16 v[68:71], a[124:127], a[28:31], v[68:71]
    v_max3_f32 v89, v89, v56, v57
    v_max3_f32 v89, v89, v58, v59
    v_max3_f32 v89, v89, v60, v61
    v_max3_f32 v89, v89, v62, v63
    v_max3_f32 v89, v89, v64, v65
    v_max3_f32 v89, v89, v66, v67
    s_nop 1
    v_max3_f32 v89, v89, v68, v69
    v_max3_f32 v89, v89, v70, v71
    v_mfma_f32_16x16x32_bf16 v[56:59], a[64:67], a[32:35], 0
    v_mfma_f32_16x16x32_bf16 v[56:59], a[68:71], a[36:39], v[56:59]
    v_mfma_f32_16x16x32_bf16 v[56:59], a[72:75], a[40:43], v[56:59]
    v_mfma_f32_16x16x32_bf16 v[56:59], a[76:79], a[44:47], v[56:59]
    v_mfma_f32_16x16x32_bf16 v[60:63], a[80:83], a[32:35], 0
    v_mfma_f32_16x16x32_bf16 v[60:63], a[84:87], a[36:39], v[60:63]
    v_mfma_f32_16x16x32_bf16 v[60:63], a[88:91], a[40:43], v[60:63]
    v_mfma_f32_16x16x32_bf16 v[60:63], a[92:95], a[44:47], v[60:63]
    v_mfma_f32_16x16x32_bf16 v[64:67], a[96:99], a[32:35], 0
    v_mfma_f32_16x16x32_bf16 v[64:67], a[100:103], a[36:39], v[64:67]
    v_mfma_f32_16x16x32_bf16 v[64:67], a[104:107], a[40:43], v[64:67]
    v_mfma_f32_16x16x32_bf16 v[64:67], a[108:111], a[44:47], v[64:67]
    v_mfma_f32_16x16x32_bf16 v[68:71], a[112:115], a[32:35], 0
    v_mfma_f32_16x16x32_bf16 v[68:71], a[116:119], a[36:39], v[68:71]
    v_mfma_f32_16x16x32_bf16 v[68:71], a[120:123], a[40:43], v[68:71]
    v_mfma_f32_16x16x32_bf16 v[68:71], a[124:127], a[44:47], v[68:71]
    v_max3_f32 v90, v90, v56, v57
    v_max3_f32 v90, v90, v58, v59
    v_max3_f32 v90, v90, v60, v61
    v_max3_f32 v90, v90, v62, v63
    v_max3_f32 v90, v90, v64, v65
    v_max3_f32 v90, v90, v66, v67
    s_nop 1
    v_max3_f32 v90, v90, v68, v69
    v_max3_f32 v90, v90, v70, v71
    v_mfma_f32_16x16x32_bf16 v[56:59], a[64:67], a[48:51], 0
    v_mfma_f32_16x16x32_bf16 v[56:59], a[68:71], a[52:55], v[56:59]
    v_mfma_f32_16x16x32_bf16 v[56:59], a[72:75], a[56:59], v[56:59]
    v_mfma_f32_16x16x32_bf16 v[56:59], a[76:79], a[60:63], v[56:59]
    v_mfma_f32_16x16x32_bf16 v[60:63], a[80:83], a[48:51], 0
    v_mfma_f32_16x16x32_bf16 v[60:63], a[84:87], a[52:55], v[60:63]
    v_mfma_f32_16x16x32_bf16 v[60:63], a[88:91], a[56:59], v[60:63]
    v_mfma_f32_16x16x32_bf16 v[60:63], a[92:95], a[60:63], v[60:63]
    v_mfma_f32_16x16x32_bf16 v[64:67], a[96:99], a[48:51], 0
    v_mfma_f32_16x16x32_bf16 v[64:67], a[100:103], a[52:55], v[64:67]
    v_mfma_f32_16x16x32_bf16 v[64:67], a[104:107], a[56:59], v[64:67]
    v_mfma_f32_16x16x32_bf16 v[64:67], a[108:111], a[60:63], v[64:67]
    v_mfma_f32_16x16x32_bf16 v[68:71], a[112:115], a[48:51], 0
    v_mfma_f32_16x16x32_bf16 v[68:71], a[116:119], a[52:55], v[68:71]
    v_mfma_f32_16x16x32_bf16 v[68:71], a[120:123], a[56:59], v[68:71]
    v_mfma_f32_16x16x32_bf16 v[68:71], a[124:127], a[60:63], v[68:71]
    v_max3_f32 v91, v91, v56, v57
    v_max3_f32 v91, v91, v58, v59
    v_max3_f32 v91, v91, v60, v61
    v_max3_f32 v91, v91, v62, v63
    v_max3_f32 v91, v91, v64, v65
    v_max3_f32 v91, v91, v66, v67
    s_nop 1
    v_max3_f32 v91, v91, v68, v69
    v_max3_f32 v91, v91, v70, v71
    s_cmp_lt_u32 s38, 524288
    s_cbranch_scc1 L_maxloop
    v_mov_b32 v192, v88
    v_mov_b32 v193, v88
    v_mov_b32 v194, v88
    v_mov_b32 v195, v88
    v_mov_b32 v196, v89
    v_mov_b32 v197, v89
    v_mov_b32 v198, v89
    v_mov_b32 v199, v89
    v_mov_b32 v200, v90
    v_mov_b32 v201, v90
    v_mov_b32 v202, v90
    v_mov_b32 v203, v90
    v_mov_b32 v204, v91
    v_mov_b32 v205, v91
    v_mov_b32 v206, v91
    v_mov_b32 v207, v91
    v_max3_f32 v192, v192, v193, v194
    v_max_f32 v192, v192, v195
    v_mov_b32 v40, v192
    s_nop 1
    v_permlane32_swap_b32 v40, v192
    v_max_f32 v192, v192, v40
    v_mov_b32 v40, v192
    s_nop 1
    v_permlane16_swap_b32 v40, v192
    v_max_f32 v192, v192, v40
    v_sub_f32 v40, 0, v192
    v_sub_f32 v41, 0, v192
    v_sub_f32 v42, 0, v192
    v_sub_f32 v43, 0, v192
    s_mov_b32 s38, 0
    s_mov_b32 s30, 0
    s_xor_b32 s32, s38, s39
    s_add_u32 m0, s33, 32768
    s_nop 0
    buffer_load_dwordx4 v8, s[8:11], s32 offen offset:0 nt lds
    buffer_load_dwordx4 v9, s[8:11], s32 offen offset:1024 nt lds
    buffer_load_dwordx4 v10, s[8:11], s32 offen offset:2048 nt lds
    buffer_load_dwordx4 v11, s[8:11], s32 offen offset:3072 nt lds
    s_add_u32 s38, s38, 16384
    s_xor_b32 s32, s38, s39
    s_add_u32 m0, s33, 49152
    s_nop 0
    buffer_load_dwordx4 v8, s[8:11], s32 offen offset:0 nt lds
    buffer_load_dwordx4 v9, s[8:11], s32 offen offset:1024 nt lds
    buffer_load_dwordx4 v10, s[8:11], s32 offen offset:2048 nt lds
    buffer_load_dwordx4 v11, s[8:11], s32 offen offset:3072 nt lds
    s_add_u32 s38, s38, 16384
    s_xor_b32 s32, s30, s39
    s_add_u32 m0, s33, 98304
    s_nop 0
    buffer_load_dwordx4 v12, s[12:15], s32 offen offset:0 nt lds
    buffer_load_dwordx4 v13, s[12:15], s32 offen offset:1024 nt lds
    buffer_load_dwordx4 v12, s[12:15], s32 offen offset:2048 nt lds
    buffer_load_dwordx4 v13, s[12:15], s32 offen offset:3072 nt lds
    s_add_u32 s30, s30, 16384
    s_xor_b32 s32, s30, s39
    s_add_u32 m0, s33, 114688
    s_nop 0
    buffer_load_dwordx4 v12, s[12:15], s32 offen offset:0 nt lds
    buffer_load_dwordx4 v13, s[12:15], s32 offen offset:1024 nt lds
    buffer_load_dwordx4 v12, s[12:15], s32 offen offset:2048 nt lds
    buffer_load_dwordx4 v13, s[12:15], s32 offen offset:3072 nt lds
    s_add_u32 s30, s30, 16384
    s_xor_b32 s32, s38, s39
    s_add_u32 m0, s33, 65536
    s_nop 0
    buffer_load_dwordx4 v8, s[8:11], s32 offen offset:0 nt lds
    buffer_load_dwordx4 v9, s[8:11], s32 offen offset:1024 nt lds
    buffer_load_dwordx4 v10, s[8:11], s32 offen offset:2048 nt lds
    buffer_load_dwordx4 v11, s[8:11], s32 offen offset:3072 nt lds
    s_add_u32 s38, s38, 16384
    s_waitcnt vmcnt(0)
    s_barrier
    ds_read_b128 a[64:67], v16 offset:0
    ds_read_b128 a[68:71], v17 offset:0
    ds_read_b128 a[72:75], v18 offset:0
    ds_read_b128 a[76:79], v19 offset:0
    ds_read_b128 a[80:83], v16 offset:4096
    ds_read_b128 a[84:87], v17 offset:4096
    ds_read_b128 a[88:91], v18 offset:4096
    ds_read_b128 a[92:95], v19 offset:4096
    s_waitcnt lgkmcnt(0)
    s_branch L_attn
.section .rodata,"a"
.p2align 6
.amdhsa_kernel concat_heads__gqa_block_cached__gqa_block_cached__near_ridge_kernel
  .amdhsa_next_free_vgpr 512
  .amdhsa_next_free_sgpr 102
  .amdhsa_accum_offset 256
  .amdhsa_group_segment_fixed_size 0
  .amdhsa_kernarg_size 104
  .amdhsa_user_sgpr_count 2
  .amdhsa_user_sgpr_kernarg_segment_ptr 1
  .amdhsa_system_sgpr_workgroup_id_x 1
  .amdhsa_float_denorm_mode_32 3
  .amdhsa_float_denorm_mode_16_64 3
.end_amdhsa_kernel
```
